```python
import torch

def _softmax(x, axis=-1):
    return torch.softmax(x, dim=axis)
def _gelu(x):
    return torch.nn.functional.gelu(x, approximate="tanh")
def _silu(x):
    return torch.nn.functional.silu(x)
def _sigmoid(x):
    return torch.sigmoid(x)
def _layernorm(x, axis=-1, eps=1e-5):
    m = x.mean(dim=axis, keepdim=True)
    v = x.var(dim=axis, keepdim=True, unbiased=False)
    return (x - m) / torch.sqrt(v + eps)
def _scatter_add(tgt, idx, src, axis=0):
    return tgt.clone().index_add_(axis, idx, src)
def _segment_sum(src, seg, n):
    out = torch.zeros((n,) + src.shape[1:], dtype=src.dtype)
    return out.index_add_(0, seg, src)
def _pad(x, pw):
    flat = tuple(v for pair in reversed(pw) for v in pair)
    return torch.nn.functional.pad(x, flat)

kernel_name = 'parallel_sum__ssm_conv_s5__mixer_channel_mlp__prompt'

def setup_inputs():

    _w = (lambda a: (lambda t: t.to(torch.bfloat16) if t.is_floating_point() else t)(torch.as_tensor(a)))
    def _A_setup():
        B, S, D = 1, 2048, 512
        P = D
        Lambda_re = -0.5 * (lambda _x: torch.exp(torch.as_tensor(_x)))((lambda *s: torch.randn(*s, dtype=torch.bfloat16) * 0.2)(P))
        Lambda_im = (lambda *s: torch.randn(*s, dtype=torch.bfloat16) * 0.8)(P) * 1.0
        B_re = (lambda *s: torch.randn(*s, dtype=torch.bfloat16) * 0.2)(P, D) * (D ** -0.5)
        B_im = (lambda *s: torch.randn(*s, dtype=torch.bfloat16) * 0.2)(P, D) * (D ** -0.5)
        C_re = (lambda *s: torch.randn(*s, dtype=torch.bfloat16) * 0.2)(D, P) * (P ** -0.5)
        C_im = (lambda *s: torch.randn(*s, dtype=torch.bfloat16) * 0.2)(D, P) * (P ** -0.5)
        log_dt = (lambda *s: torch.randn(*s, dtype=torch.bfloat16) * 0.2)(P) * 0.3 - 2.0
        Dskip = (lambda *s: torch.randn(*s, dtype=torch.bfloat16) * 0.05)(D)
        return {
            "x": _w((lambda *s: torch.randn(*s, dtype=torch.bfloat16) * 0.05)(B, S, D)),
            "Lambda_re": _w(Lambda_re),
            "Lambda_im": _w(Lambda_im),
            "B_re": _w(B_re),
            "B_im": _w(B_im),
            "C_re": _w(C_re),
            "C_im": _w(C_im),
            "log_dt": _w(log_dt),
            "Dskip": _w(Dskip),
        }
    _A_in = _A_setup()

    def _B_setup():
        B, S, D, F = 1, 2048, 512, 1792
        return {
            "x": _w((lambda *s: torch.randn(*s, dtype=torch.bfloat16) * 0.05)(B, S, D)),
            "w1": _w((lambda *s: torch.randn(*s, dtype=torch.bfloat16) * 1.6)(D, F) * (D ** -0.5)),
            "b1": _w((lambda *s: torch.randn(*s, dtype=torch.bfloat16) * 0.8)(F)),
            "w2": _w((lambda *s: torch.randn(*s, dtype=torch.bfloat16) * 0.05)(F, D) * (F ** -0.5)),
            "b2": _w((lambda *s: torch.randn(*s, dtype=torch.bfloat16) * 0.05)(D)),
        }
    _B_in = _B_setup()

    return {
        "A_x": _A_in["x"],
        "A_Lambda_re": _A_in["Lambda_re"],
        "A_Lambda_im": _A_in["Lambda_im"],
        "A_B_re": _A_in["B_re"],
        "A_B_im": _A_in["B_im"],
        "A_C_re": _A_in["C_re"],
        "A_C_im": _A_in["C_im"],
        "A_log_dt": _A_in["log_dt"],
        "A_Dskip": _A_in["Dskip"],
        "B_x": _B_in["x"],
        "B_w1": _B_in["w1"],
        "B_b1": _B_in["b1"],
        "B_w2": _B_in["w2"],
        "B_b2": _B_in["b2"],
    }

def reference(A_x, A_Lambda_re, A_Lambda_im, A_B_re, A_B_im, A_C_re, A_C_im, A_log_dt, A_Dskip, B_x, B_w1, B_b1, B_w2, B_b2):
    def _A_ref(x, Lambda_re, Lambda_im, B_re, B_im, C_re, C_im, log_dt, Dskip):
        Bsz, L, H = x.shape
        Lam = Lambda_re + 1j * Lambda_im
        Bmat = B_re + 1j * B_im
        Cmat = C_re + 1j * C_im
        dt = torch.exp(log_dt)
        Lam_bar = torch.exp(dt * Lam)
        B_bar = ((Lam_bar - 1.0) / Lam)[:, None] * Bmat
        Bu = torch.einsum("bld,pd->blp", x + 0j, B_bar)
        h = torch.zeros_like(Bu[:, 0, :])
        hs = []
        for t in range(L):
            h = Lam_bar[None, :] * h + Bu[:, t, :]
            hs.append(h)
        hseq = torch.stack(hs, 1)
        y = 2.0 * torch.einsum("blp,dp->bld", hseq, Cmat).real + x * Dskip[None, None, :]
        return y

    def _B_ref(x, w1, b1, w2, b2):
        y = _layernorm(x, axis=-1)
        h = _gelu(torch.einsum("bsd,df->bsf", y, w1) + b1)
        return torch.einsum("bsf,fd->bsd", h, w2) + b2

    x = A_x
    xn = _layernorm(x, axis=-1)
    return x + _A_ref(xn, A_Lambda_re, A_Lambda_im, A_B_re, A_B_im, A_C_re, A_C_im, A_log_dt, A_Dskip) + _B_ref(xn, B_w1, B_b1, B_w2, B_b2)
```

```asm
; @launch grid=(256,1,1) block=(256,1,1) lds=163840
.amdgcn_target "amdgcn-amd-amdhsa--gfx950"
.text
.globl parallel_sum__ssm_conv_s5__mixer_channel_mlp__prompt_kernel
.p2align 8
.type parallel_sum__ssm_conv_s5__mixer_channel_mlp__prompt_kernel,@function
parallel_sum__ssm_conv_s5__mixer_channel_mlp__prompt_kernel:
  s_load_dwordx2 s[4:5], s[0:1], 0
  s_load_dwordx2 s[16:17], s[0:1], 80
  s_load_dwordx2 s[32:33], s[0:1], 128
  s_getpc_b64 s[90:91]
  s_bfe_u32 s3, s2, 0x30003
  v_and_or_b32 v4, v0, -8, s3
  v_lshlrev_b32 v4, 7, v4
  v_min_u32 v4, L_end-parallel_sum__ssm_conv_s5__mixer_channel_mlp__prompt_kernel-64, v4
  global_load_dword v16, v4, s[90:91]
  s_cmpk_ge_u32 s2, 256
  s_cbranch_scc1 L_end
  s_load_dwordx2 s[8:9], s[0:1], 24
  s_load_dwordx2 s[12:13], s[0:1], 32
  s_load_dwordx4 s[48:51], s[0:1], 8
  s_load_dwordx4 s[52:55], s[0:1], 56
  v_lshrrev_b32 v5, 6, v0
  v_and_b32 v1, 63, v0
  s_mov_b32 s6, 0x200000
  v_readfirstlane_b32 s64, v5
  s_mov_b32 s7, 0x20000
  s_and_b32 s68, s2, 4
  s_lshr_b32 s69, s2, 5
  s_lshl1_add_u32 s60, s68, s69
  s_and_b32 s62, s2, 3
  s_bfe_u32 s63, s2, 0x20003
  s_lshl2_add_u32 s61, s62, s63
  v_lshrrev_b32 v3, 5, v1
  s_and_b32 s65, s64, 1
  s_mov_b32 s10, 0x80000
  s_mov_b32 s11, s7
  v_lshrrev_b32 v6, 3, v1
  v_and_b32 v7, 7, v1
  v_lshrrev_b32 v8, 4, v1
  v_xor_b32 v7, v7, v8
  v_lshlrev_b32 v7, 4, v7
  v_and_b32 v9, 1, v8
  v_and_or_b32 v9, v1, 8, v9
  v_lshl_add_u32 v9, v3, 4, v9
  v_lshl_add_u32 v9, v9, 10, v7
  s_lshl2_add_u32 s68, s60, s64
  s_lshl_b32 s68, s68, 15
  s_lshl_b32 s67, s64, 12
  v_add_u32 v17, s68, v9
  v_xor_b32 v18, 64, v17
  v_add_u32 v19, 2048, v17
  v_add_u32 v18, 1024, v18
  s_mov_b64 s[14:15], s[10:11]
  v_add_u32 v20, 2048, v18
  s_add_u32 m0, s67, 65536
  s_movk_i32 s70, 0
  s_waitcnt lgkmcnt(0)
  buffer_load_dwordx4 v17, s[4:7], s70 offen offset:0 lds
  buffer_load_dwordx4 v18, s[4:7], s70 offen offset:1024 lds
  buffer_load_dwordx4 v19, s[4:7], s70 offen offset:2048 lds
  buffer_load_dwordx4 v20, s[4:7], s70 offen offset:3072 lds
  s_lshl_b32 s66, s64, 10
  s_lshl_b32 s69, s65, 6
  v_xor_b32 v9, s69, v7
  v_lshl_add_u32 v9, v6, 10, v9
  s_lshl_b32 s69, s64, 13
  v_add_u32 v26, s69, v9
  s_and_b32 s69, s64, 2
  s_lshl2_add_u32 s69, s61, s69
  s_lshl1_add_u32 s69, s69, s65
  s_lshl_b32 s69, s69, 12
  v_lshl_add_u32 v9, v3, 12, v9
  s_add_u32 m0, s66, 114688
  v_add_u32 v21, s69, v9
  buffer_load_dwordx4 v21, s[8:11], s70 offen lds
  s_add_u32 m0, s66, 118784
  s_nop 0
  buffer_load_dwordx4 v21, s[12:15], s70 offen lds
  s_load_dwordx2 s[44:45], s[0:1], 120
  s_memrealtime s[92:93]
  s_load_dwordx2 s[20:21], s[0:1], 96
  s_load_dwordx2 s[24:25], s[0:1], 40
  s_load_dwordx2 s[28:29], s[0:1], 48
  v_and_b32 v2, 31, v1
  s_lshr_b32 s68, s64, 1
  s_lshl1_add_u32 s68, s62, s68
  s_lshl3_add_u32 s68, s60, s68
  s_lshl3_add_u32 s68, s68, s63
  s_lshl1_add_u32 s68, s68, s65
  s_lshl_b32 s73, s68, 10
  v_lshlrev_b32 v44, 4, v2
  v_lshl_add_u32 v44, v3, 13, v44
  s_lshl4_add_u32 s69, s61, s60
  s_lshl1_add_u32 s69, s69, s65
  s_lshl_b32 s74, s69, 10
  v_lshlrev_b32 v46, 4, v1
  s_mov_b64 s[42:43], s[10:11]
  buffer_load_dwordx4 v[28:31], v44, s[4:7], s73 offen
  buffer_load_dwordx4 v[32:35], v44, s[4:7], s73 offen offset:512
  s_cmp_lt_u32 s64, 2
  s_cselect_b64 s[40:41], s[8:9], s[12:13]
  buffer_load_dwordx4 v[36:39], v46, s[40:43], s74 offen
  s_lshl2_add_u32 s68, s60, s63
  s_lshl2_add_u32 s68, s68, s64
  s_lshl3_add_u32 s68, s68, s62
  s_mul_i32 s77, s68, 896
  v_bfe_u32 v4, v1, 2, 3
  v_min_u32 v4, 6, v4
  v_mul_u32_u24 v45, 3584, v3
  v_lshl_add_u32 v45, v4, 7, v45
  s_mov_b32 s18, 1835008
  s_mov_b32 s19, s7
  buffer_load_dword v47, v45, s[16:19], s77 offen
  s_movk_i32 s46, 128
  s_mov_b32 s47, s7
  s_waitcnt lgkmcnt(0)
  s_cmp_eq_u32 s2, 5
  s_cbranch_scc1 L_pub
L_pubr:
  s_load_dwordx2 s[56:57], s[0:1], 88
  s_load_dwordx2 s[58:59], s[0:1], 104
  s_load_dwordx2 s[36:37], s[0:1], 112
  v_bfe_u32 v4, v1, 1, 3
  v_xor_b32 v4, v4, v3
  v_lshlrev_b32 v4, 4, v4
  v_lshl_add_u32 v55, v2, 7, v4
  s_lshl_b32 s69, s64, 5
  v_xor_b32 v4, s69, v55
  s_add_u32 s68, s67, 65536
  v_add_u32 v57, s68, v4
  v_add_u32 v61, 114688, v4
  v_xor_b32 v58, 32, v57
  v_xor_b32 v62, 32, v61
  v_xor_b32 v59, 64, v57
  v_xor_b32 v63, 64, v61
  v_xor_b32 v60, 96, v57
  v_xor_b32 v64, 96, v61
  s_lshl2_add_u32 s71, s63, s62
  s_lshr_b32 s72, s71, 1
  v_mul_u32_u24 v4, 24, v3
  v_xor_b32 v4, v4, v55
  s_and_b32 s69, s71, 1
  s_lshl_b32 s69, s69, 6
  s_add_u32 s68, s68, s69
  v_xor_b32 v65, s68, v4
  s_lshl_b32 s68, s61, 6
  v_lshrrev_b32 v4, 1, v2
  v_xor_b32 v4, v4, v2
  v_and_b32 v4, 4, v4
  v_mul_u32_u24 v4, 3, v4
  v_xor_b32 v49, v4, v2
  v_lshl_add_u32 v53, v49, 1, s68
  global_load_ushort v51, v53, s[48:49]
  global_load_ushort v52, v53, s[50:51]
  global_load_ushort v53, v53, s[52:53]
  s_mov_b32 s34, 41943040
  s_mov_b32 s35, s7
  s_lshl4_add_u32 s68, s60, s61
  s_lshl3_add_u32 s69, s68, s64
  s_lshl_b32 s69, s69, 5
  s_add_u32 s69, s69, 35127296
  v_cmp_eq_u32 vcc, 0, v2
  v_lshl_add_u32 v5, v3, 4, s69
  v_mov_b32 v4, 0x7ffffff0
  s_lshl4_add_u32 s68, s68, s64
  s_lshl_b32 s68, s68, 4
  s_add_u32 s68, s68, 35127424
  v_cndmask_b32 v48, v4, v5, vcc
  v_writelane_b32 v48, s68, 1
  buffer_load_dword v47, v48, s[32:35], 0 offen
  s_and_b32 s65, s61, 1
  v_bfe_u32 v6, v1, 2, 2
  v_xor_b32 v27, v6, v8
  v_and_b32 v7, 3, v1
  v_lshlrev_b32 v7, 4, v7
  v_lshl_add_u32 v9, v27, 6, v7
  v_cmp_eq_u32 vcc, 3, v27
  s_mul_i32 s69, s65, 224
  s_sub_u32 s69, 192, s69
  v_add_u32 v10, s69, v7
  v_cndmask_b32 v10, v9, v10, vcc
  v_cmp_le_u32 vcc, 224, v9
  v_mul_u32_u24 v9, 3584, v8
  s_mul_i32 s68, s64, 57344
  s_mul_i32 s69, s61, 224
  s_add_u32 s68, s68, s69
  s_lshl_b32 s69, s65, 5
  s_add_u32 s68, s68, s69
  v_add3_u32 v9, v9, v10, s68
  v_mov_b32 v4, 0x70000000
  v_cndmask_b32 v22, v9, v4, vcc
  v_add_u32 v23, 13312, v22
  v_add_u32 v24, 26624, v22
  v_add_u32 v25, 39936, v22
  v_mul_u32_u24 v5, 320, v6
  v_and_b32 v9, 16, v1
  v_lshl_add_u32 v5, v9, 1, v5
  v_lshrrev_b32 v7, 1, v7
  v_add_u32 v56, v7, v5
  s_waitcnt lgkmcnt(0) vmcnt(8)
  s_barrier
  s_cmp_eq_u32 s72, 0
  s_cbranch_scc1 L_xb0
L_xr0:
  ds_read_b128 a[36:39], v57 offset:0
  ds_read_b128 a[40:43], v58 offset:0
  ds_read_b128 a[164:167], v61 offset:0
  ds_read_b128 a[44:47], v59 offset:0
  ds_read_b128 a[48:51], v60 offset:0
  ds_read_b128 a[168:171], v61 offset:4096
  ds_read_b128 a[172:175], v62 offset:0
  ds_read_b128 a[176:179], v62 offset:4096
  ds_read_b128 a[180:183], v63 offset:0
  ds_read_b128 a[184:187], v63 offset:4096
  ds_read_b128 a[188:191], v64 offset:0
  s_waitcnt lgkmcnt(3)
  v_mfma_f32_32x32x16_bf16 v[140:155], a[36:39], a[164:167], 0
  ds_read_b128 a[192:195], v64 offset:4096
  s_add_u32 m0, s67, 81920
  s_movk_i32 s70, 128
  buffer_load_dwordx4 v17, s[4:7], s70 offen offset:0 lds
  v_lshl_add_u32 v7, v3, 11, v56
  v_add_u32 v84, s67, v7
  v_xor_b32 v85, 64, v84
  v_xor_b32 v86, 128, v84
  v_xor_b32 v87, 192, v84
  v_xor_b32 v88, 4096, v84
  v_xor_b32 v89, 4160, v84
  v_mfma_f32_32x32x16_bf16 v[156:171], a[36:39], a[168:171], 0
  buffer_load_dwordx4 v18, s[4:7], s70 offen offset:1024 lds
  v_xor_b32 v90, 4224, v84
  v_xor_b32 v91, 4288, v84
  v_xor_b32 v92, 8192, v84
  v_xor_b32 v93, 8256, v84
  v_xor_b32 v94, 8320, v84
  v_xor_b32 v95, 8384, v84
  v_xor_b32 v96, 12288, v84
  v_xor_b32 v97, 12352, v84
  v_xor_b32 v98, 12416, v84
  v_xor_b32 v99, 12480, v84
  v_lshrrev_b32 v4, 2, v1
  v_mfma_f32_32x32x16_bf16 v[140:155], a[40:43], a[172:175], v[140:155]
  v_xor_b32 v4, v4, v1
  v_and_b32 v4, 4, v4
  v_cmp_eq_u32 vcc, 0, v4
  v_mov_b32 v5, 0x3f803f80
  v_mov_b32 v68, 0
  v_cndmask_b32 v4, 0, v5, vcc
  v_accvgpr_write_b32 a0, v4
  v_accvgpr_write_b32 a1, v4
  v_accvgpr_write_b32 a2, v4
  v_accvgpr_write_b32 a3, v4
  s_mul_i32 s68, s61, 224
  s_lshl_b32 s69, s65, 5
  v_mfma_f32_32x32x16_bf16 v[156:171], a[40:43], a[176:179], v[156:171]
  s_waitcnt lgkmcnt(0)
  s_add_u32 s69, s69, s68
  v_lshl_add_u32 v77, v2, 1, s69
  s_mul_i32 s69, s65, 192
  s_sub_u32 s69, s68, s69
  s_add_u32 s69, s69, 192
  v_and_b32 v6, 15, v1
  v_lshl_add_u32 v79, v6, 1, s69
  s_lshl_b32 s68, s71, 6
  v_lshl_add_u32 v80, v2, 1, s68
  v_mov_b32 v69, 0
  v_mov_b32 v71, 0
  v_mfma_f32_32x32x16_bf16 v[140:155], a[44:47], a[180:183], v[140:155]
  v_mov_b32 v81, 0
  v_min_u32 v4, 223, v0
  v_lshlrev_b32 v4, 3, v4
  v_add_u32 v4, 159744, v4
  s_mov_b64 s[22:23], s[18:19]
  s_mov_b64 s[26:27], s[10:11]
  s_mov_b64 s[30:31], s[10:11]
  s_mov_b32 s38, 0x400000
  s_mov_b32 s39, s7
  s_movk_i32 s42, 8192
  s_lshl_b32 s68, s61, 13
  s_add_u32 s68, s68, 33554432
  v_mfma_f32_32x32x16_bf16 v[156:171], a[44:47], a[184:187], v[156:171]
  ds_write_b64 v4, v[68:69]
  s_add_u32 s40, s32, s68
  s_addc_u32 s41, s33, 0
  s_lshl4_add_u32 s68, s62, s60
  s_lshl1_add_u32 s68, s68, s64
  s_mul_i32 s68, s68, 56
  s_add_u32 s68, s68, s63
  s_lshl4_add_u32 s69, s63, s60
  s_lshl_b32 s69, s69, 5
  s_add_u32 s69, s69, s62
  s_cmp_eq_u32 s64, 2
  s_cselect_b64 s[90:91], s[24:25], s[28:29]
  s_cmp_lt_u32 s64, 2
  s_cselect_b64 s[90:91], s[20:21], s[90:91]
  s_cselect_b32 s68, s68, s69
  s_cselect_b32 s69, 27, 15
  s_lshl_b32 s68, s68, 8
  v_min_u32 v4, s69, v1
  v_and_b32 v46, 1, v4
  v_lshl_add_u32 v46, v46, 7, s68
  v_lshrrev_b32 v4, 1, v4
  v_lshl_add_u32 v46, v4, 10, v46
  buffer_load_dwordx4 v19, s[4:7], s70 offen offset:2048 lds
  buffer_load_dwordx4 v20, s[4:7], s70 offen offset:3072 lds
  s_add_u32 m0, s66, 122880
  s_nop 0
  buffer_load_dwordx4 v21, s[8:11], s70 offen lds
  s_add_u32 m0, s66, 126976
  s_nop 0
  buffer_load_dwordx4 v21, s[12:15], s70 offen lds
  v_mov_b32 v4, 0
  v_mov_b32 v5, 0
  v_mov_b32 v9, 0
  s_mov_b32 s68, 0x3f803f80
  s_waitcnt vmcnt(13)
  v_dot2c_f32_bf16 v4, s68, v28
  v_dot2c_f32_bf16 v5, v28, v28
  v_dot2c_f32_bf16 v4, s68, v29
  v_dot2c_f32_bf16 v5, v29, v29
  v_dot2c_f32_bf16 v4, s68, v30
  v_dot2c_f32_bf16 v5, v30, v30
  v_dot2c_f32_bf16 v4, s68, v31
  v_dot2c_f32_bf16 v5, v31, v31
  s_waitcnt vmcnt(12)
  v_dot2c_f32_bf16 v4, s68, v32
  v_dot2c_f32_bf16 v5, v32, v32
  v_dot2c_f32_bf16 v4, s68, v33
  v_dot2c_f32_bf16 v5, v33, v33
  v_dot2c_f32_bf16 v4, s68, v34
  v_dot2c_f32_bf16 v5, v34, v34
  v_dot2c_f32_bf16 v4, s68, v35
  v_dot2c_f32_bf16 v5, v35, v35
  s_waitcnt vmcnt(11)
  v_dot2c_f32_bf16 v9, s68, v36
  v_dot2c_f32_bf16 v9, s68, v37
  v_dot2c_f32_bf16 v9, s68, v38
  v_dot2c_f32_bf16 v9, s68, v39
  v_add_f32_dpp v4, v4, v4 row_ror:8 row_mask:0xf bank_mask:0xf
  v_add_f32_dpp v5, v5, v5 row_ror:8 row_mask:0xf bank_mask:0xf
  s_nop 0
  v_add_f32_dpp v9, v9, v9 row_ror:8 row_mask:0xf bank_mask:0xf
  v_add_f32_dpp v4, v4, v4 row_ror:4 row_mask:0xf bank_mask:0xf
  v_add_f32_dpp v5, v5, v5 row_ror:4 row_mask:0xf bank_mask:0xf
  v_add_f32_dpp v9, v9, v9 row_ror:4 row_mask:0xf bank_mask:0xf
  v_add_f32_dpp v4, v4, v4 row_ror:2 row_mask:0xf bank_mask:0xf
  v_add_f32_dpp v5, v5, v5 row_ror:2 row_mask:0xf bank_mask:0xf
  v_add_f32_dpp v9, v9, v9 row_ror:2 row_mask:0xf bank_mask:0xf
  v_add_f32_dpp v4, v4, v4 row_ror:1 row_mask:0xf bank_mask:0xf
  v_add_f32_dpp v5, v5, v5 row_ror:1 row_mask:0xf bank_mask:0xf
  v_add_f32_dpp v9, v9, v9 row_ror:1 row_mask:0xf bank_mask:0xf
  v_mov_b32 v6, v4
  v_mov_b32 v7, v5
  v_mov_b32 v10, v9
  v_permlane16_swap_b32 v4, v6
  v_permlane16_swap_b32 v5, v7
  v_permlane16_swap_b32 v9, v10
  v_add_f32 v4, v4, v6
  v_add_f32 v5, v5, v7
  v_add_f32 v9, v9, v10
  v_mul_f32 v4, 0x3b000000, v4
  v_mov_b32 v10, v9
  v_mul_f32 v5, 0x3b000000, v5
  v_fma_f32 v5, -v4, v4, v5
  v_permlane32_swap_b32 v9, v10
  v_max_f32 v5, 0, v5
  v_add_f32 v9, v9, v10
  v_cvt_pk_bf16_f32 v6, v5, v5
  v_lshlrev_b32 v6, 16, v6
  v_add_f32 v6, 0x3727c5ac, v6
  v_cvt_pk_bf16_f32 v6, v6, v6
  v_lshlrev_b32 v6, 16, v6
  v_sqrt_f32 v6, v6
  v_and_b32 v10, 0xffff0000, v9
  v_cvt_pk_bf16_f32 v40, v4, v6
  s_add_u32 m0, s67, 0
  s_mov_b32 s70, 0
  buffer_load_dwordx4 v22, s[16:19], s70 offen offset:0 lds
  v_and_b32 v6, 0xffff0000, v40
  v_rcp_f32 v6, v6
  v_lshlrev_b32 v7, 16, v40
  v_sub_f32 v4, v4, v7
  v_mul_f32 v5, v5, v6
  v_mul_f32 v5, v5, v6
  v_cvt_pk_bf16_f32 v5, v5, v5
  v_lshlrev_b32 v5, 16, v5
  v_add_f32 v5, 0x3727c5ac, v5
  v_cvt_pk_bf16_f32 v5, v5, v5
  v_lshlrev_b32 v5, 16, v5
  v_sqrt_f32 v5, v5
  buffer_load_dwordx4 v23, s[16:19], s70 offen offset:1024 lds
  v_mul_f32 v4, v4, v6
  v_cvt_pk_bf16_f32 v42, v4, v5
  v_cmp_eq_u32 vcc, 1, v1
  v_sub_f32 v9, v9, v10
  v_cvt_pk_bf16_f32 v9, v10, v9
  v_cndmask_b32 v40, v40, v9, vcc
  s_lshl2_add_u32 s68, s60, s64
  s_lshl_b32 s68, s68, 10
  s_add_u32 s68, s68, 35127296
  v_and_b32 v4, 24, v2
  v_add_u32 v4, v4, v2
  v_lshl_add_u32 v44, v4, 4, s68
  s_lshl_b32 s68, s61, 8
  s_add_u32 s68, s68, 35127424
  v_lshrrev_b32 v4, 1, v49
  v_lshl_add_u32 v4, v4, 12, s68
  v_and_b32 v5, 1, v2
  v_lshl_add_u32 v5, v3, 1, v5
  v_lshl_add_u32 v49, v5, 4, v4
  buffer_load_dwordx4 v24, s[16:19], s70 offen offset:2048 lds
  buffer_load_dwordx4 v25, s[16:19], s70 offen offset:3072 lds
  s_add_u32 m0, s67, 98304
  s_movk_i32 s70, 256
  buffer_load_dwordx4 v17, s[4:7], s70 offen offset:0 lds
  s_waitcnt vmcnt(5)
  s_barrier
  s_cmp_eq_u32 s72, 1
  s_cbranch_scc1 L_xb1
L_xr1:
  v_mfma_f32_32x32x16_bf16 v[140:155], a[48:51], a[188:191], v[140:155]
  ds_read_b128 a[52:55], v57 offset:16384
  ds_read_b128 a[56:59], v58 offset:16384
  ds_read_b128 a[196:199], v61 offset:8192
  ds_read_b128 a[60:63], v59 offset:16384
  ds_read_b128 a[64:67], v60 offset:16384
  ds_read_b128 a[200:203], v61 offset:12288
  v_and_b32 v11, 4, v2
  v_lshrrev_b32 v12, 3, v2
  v_add_u32 v11, v11, v12
  v_and_b32 v12, 3, v2
  v_lshl_add_u32 v11, v11, 2, v12
  s_lshl_b32 s73, s64, 7
  v_mfma_f32_32x32x16_bf16 v[156:171], a[48:51], a[192:195], v[156:171]
  ds_read_b128 a[204:207], v62 offset:8192
  ds_read_b128 a[208:211], v62 offset:12288
  buffer_load_dwordx4 v18, s[4:7], s70 offen offset:1024 lds
  s_load_dwordx2 s[50:51], s[44:45], 0
  s_add_u32 s73, s73, 158720
  v_lshl_add_u32 v126, v11, 2, s73
  v_lshl_add_u32 v127, v3, 6, s73
  v_lshlrev_b32 v11, 3, v2
  v_add_u32 v82, 155648, v11
  s_mul_i32 s73, s64, 132
  s_and_b32 s73, s73, 0x104
  v_add_u32 v83, s73, v82
  s_waitcnt lgkmcnt(5)
  v_mfma_f32_32x32x16_bf16 v[140:155], a[52:55], a[196:199], v[140:155]
  buffer_load_dwordx4 v19, s[4:7], s70 offen offset:2048 lds
  v_lshlrev_b32 v11, 3, v0
  v_add_u32 v132, 159744, v11
  v_mov_b32 v11, 0x7ffffff0
  s_sub_u32 s74, 15, s60
  s_lshl_b32 s74, s74, 8
  v_lshl_add_u32 v124, v2, 3, s74
  v_lshrrev_b32 v12, 5, v0
  v_cmp_le_u32 s[48:49], 6, v12
  v_lshl_add_u32 v125, v12, 9, v124
  v_xor_b32 v12, 1, v3
  v_lshl_add_u32 v124, v12, 12, v124
  s_waitcnt lgkmcnt(2)
  v_mfma_f32_32x32x16_bf16 v[156:171], a[52:55], a[200:203], v[156:171]
  buffer_load_dwordx4 v20, s[4:7], s70 offen offset:3072 lds
  v_cndmask_b32 v124, v11, v124, s[48:49]
  v_cmp_eq_u32 s[48:49], 0, v1
  s_lshl2_add_u32 s73, s60, s62
  s_lshl2_add_u32 s73, s73, s64
  s_lshl_b32 s73, s73, 9
  s_add_u32 s92, s73, 34603008
  s_lshl3_add_u32 s74, s63, s92
  v_mov_b32 v12, s74
  v_cndmask_b32 v133, v11, v12, s[48:49]
  s_lshl2_add_u32 s73, s60, s63
  s_lshl2_add_u32 s73, s73, s64
  s_add_u32 m0, s66, 131072
  s_nop 0
  buffer_load_dwordx4 v21, s[8:11], s70 offen lds
  s_add_u32 m0, s66, 135168
  s_nop 0
  buffer_load_dwordx4 v21, s[12:15], s70 offen lds
  s_add_u32 m0, s67, 65536
  s_movk_i32 s70, 384
  buffer_load_dwordx4 v17, s[4:7], s70 offen offset:0 lds
  buffer_load_dwordx4 v18, s[4:7], s70 offen offset:1024 lds
  s_waitcnt vmcnt(8)
  s_barrier
  s_waitcnt lgkmcnt(1)
  v_mfma_f32_32x32x16_bf16 v[140:155], a[56:59], a[204:207], v[140:155]
  ds_read_b64_tr_b16 a[164:165], v84 offset:0
  ds_read_b64_tr_b16 a[166:167], v84 offset:1024
  ds_read_b64_tr_b16 a[168:169], v85 offset:0
  ds_read_b64_tr_b16 a[170:171], v85 offset:1024
  s_lshl_b32 s73, s73, 9
  s_add_u32 s93, s73, 34734080
  v_mov_b32 v12, s93
  v_cndmask_b32 v134, v11, v12, s[48:49]
  s_lshl_b32 s73, s63, 7
  s_add_u32 s73, s73, s92
  s_lshl_b32 s74, s62, 7
  s_add_u32 s93, s74, s93
  s_waitcnt lgkmcnt(4)
  v_mfma_f32_32x32x16_bf16 v[156:171], a[56:59], a[208:211], v[156:171]
  ds_read_b64_tr_b16 a[172:173], v86 offset:0
  ds_read_b64_tr_b16 a[174:175], v86 offset:1024
  ds_read_b64_tr_b16 a[176:177], v87 offset:0
  ds_read_b64_tr_b16 a[178:179], v87 offset:1024
  v_mov_b32 v11, s73
  v_mov_b32 v12, s93
  v_cndmask_b32 v50, v11, v12, s[48:49]
  v_lshlrev_b32 v53, 16, v53
  v_lshlrev_b32 v51, 16, v51
  v_mul_f32 v53, 0x3fb8aa3b, v53
  v_exp_f32 v53, v53
  s_waitcnt lgkmcnt(6)
  v_mfma_f32_32x32x16_bf16 v[172:187], a[164:167], a[36:39], 0
  ds_read_b128 a[180:183], v63 offset:8192
  ds_read_b128 a[184:187], v63 offset:12288
  buffer_load_dwordx4 v19, s[4:7], s70 offen offset:2048 lds
  v_lshlrev_b32 v52, 16, v52
  v_cvt_pk_bf16_f32 v53, v53, v53
  v_lshlrev_b32 v53, 16, v53
  v_mul_f32 v11, v53, v51
  v_mul_f32 v12, v53, v52
  v_mul_f32 v11, 0x3fb8aa3b, v11
  v_mul_f32 v12, 0.15915494, v12
  v_exp_f32 v11, v11
  v_mfma_f32_16x16x32_bf16 a[20:23], a[0:3], a[164:167], 0
  v_rndne_f32 v13, v12
  v_sub_f32 v12, v12, v13
  s_waitcnt lgkmcnt(6)
  v_mfma_f32_32x32x16_bf16 v[188:203], a[168:171], a[36:39], 0
  ds_read_b128 a[188:191], v64 offset:8192
  ds_read_b128 a[192:195], v64 offset:12288
  v_cos_f32 v13, v12
  v_sin_f32 v14, v12
  v_mul_f32 v15, v51, v51
  v_mul_f32 v108, v11, v13
  v_mul_f32 v109, v11, v14
  v_fma_f32 v15, v52, v52, v15
  v_rcp_f32 v11, v15
  v_mfma_f32_16x16x32_bf16 a[24:27], a[0:3], a[168:171], 0
  buffer_load_dwordx4 v20, s[4:7], s70 offen offset:3072 lds
  v_add_f32 v12, -1.0, v108
  s_waitcnt lgkmcnt(6)
  v_mfma_f32_32x32x16_bf16 v[204:219], a[172:175], a[36:39], 0
  ds_read_b64_tr_b16 a[196:197], v88 offset:0
  ds_read_b64_tr_b16 a[198:199], v88 offset:1024
  ds_read_b64_tr_b16 a[200:201], v89 offset:0
  ds_read_b64_tr_b16 a[202:203], v89 offset:1024
  s_waitcnt lgkmcnt(0)
  s_and_b32 s68, s50, s51
  s_bitcmp0_b32 s68, 31
  s_cbranch_scc1 L_sp1
L_ok1:
  v_add_f32 v11, v11, v11
  v_mul_f32 v13, v12, v51
  v_fma_f32 v13, v109, v52, v13
  s_add_u32 m0, s66, 139264
  v_mfma_f32_16x16x32_bf16 a[28:31], a[0:3], a[172:175], 0
  buffer_load_dwordx4 v21, s[8:11], s70 offen lds
  v_mfma_f32_32x32x16_bf16 v[220:235], a[176:179], a[36:39], 0
  ds_read_b64_tr_b16 a[204:205], v90 offset:0
  ds_read_b64_tr_b16 a[206:207], v90 offset:1024
  v_mov_b32 v41, s50
  v_mov_b32 v43, s51
  buffer_store_dwordx4 v[40:43], v48, s[32:35], 0 offen sc1
  v_mul_f32 v14, v109, v51
  v_fma_f32 v14, v12, v52, -v14
  v_mul_f32 v120, v13, v11
  v_mul_f32 v121, v14, v11
  v_sub_f32 v109, 0, v109
  v_mul_f32 v11, v109, v109
  v_mul_f32 v12, v108, v109
  v_mfma_f32_16x16x32_bf16 a[32:35], a[0:3], a[176:179], 0
  s_mul_i32 s68, s51, 0x9e3779b1
  v_mfma_f32_32x32x16_bf16 v[140:155], a[60:63], a[180:183], v[140:155]
  ds_read_b64_tr_b16 a[208:209], v91 offset:0
  ds_read_b64_tr_b16 a[210:211], v91 offset:1024
  v_mov_b32 v66, s50
  s_xor_b32 s68, s68, s50
  v_mov_b32 v67, s51
  v_fma_f32 v11, v108, v108, -v11
  v_add_f32 v12, v12, v12
  v_mul_f32 v13, v12, v12
  v_mul_f32 v14, v11, v12
  v_fma_f32 v13, v11, v11, -v13
  v_add_f32 v14, v14, v14
  v_mul_f32 v110, v14, v14
  s_add_u32 m0, s66, 143360
  v_mfma_f32_32x32x16_bf16 v[156:171], a[60:63], a[184:187], v[156:171]
  buffer_load_dwordx4 v21, s[12:15], s70 offen lds
  s_mul_i32 s68, s68, 0x9e3779b1
  v_and_b32 v4, 3, v1
  v_lshlrev_b32 v4, 3, v4
  v_mul_f32 v111, v13, v14
  v_fma_f32 v110, v13, v13, -v110
  v_add_f32 v111, v111, v111
  v_mul_f32 v112, v111, v111
  v_mul_f32 v113, v110, v111
  v_fma_f32 v112, v110, v110, -v112
  v_add_f32 v113, v113, v113
  v_mfma_f32_32x32x16_bf16 v[140:155], a[64:67], a[188:191], v[140:155]
  s_add_u32 m0, s67, 81920
  s_movk_i32 s70, 512
  buffer_load_dwordx4 v17, s[4:7], s70 offen offset:0 lds
  v_alignbit_b32 v5, s68, s68, v4
  s_mov_b32 s47, s68
  s_lshl_b32 s73, s63, 6
  v_xor_b32 v11, s73, v26
  s_lshl_b32 s73, s63, 17
  s_lshl_b32 s74, s62, 8
  s_add_u32 s73, s73, s74
  v_add_u32 v136, s73, v11
  v_xor_b32 v26, 128, v136
  v_mfma_f32_32x32x16_bf16 v[156:171], a[64:67], a[192:195], v[156:171]
  s_waitcnt lgkmcnt(0)
  buffer_load_dwordx4 v18, s[4:7], s70 offen offset:1024 lds
  v_and_b32 v137, 0x3ff, v5
  s_lshl_b32 s89, s62, 15
  s_xor_b32 s86, s89, 98304
  s_xor_b32 s87, s89, 65536
  s_xor_b32 s88, s89, 32768
  v_mul_f32 v11, v113, v113
  v_mul_f32 v12, v112, v113
  v_fma_f32 v11, v112, v112, -v11
  v_add_f32 v12, v12, v12
  v_cmp_eq_u32 s[48:49], 1, v3
  v_mfma_f32_32x32x16_bf16 v[172:187], a[196:199], a[40:43], v[172:187]
  buffer_load_dwordx4 v19, s[4:7], s70 offen offset:2048 lds
  v_mul_f32 v13, v12, v12
  v_mul_f32 v14, v11, v12
  v_fma_f32 v13, v11, v11, -v13
  v_add_f32 v14, v14, v14
  v_cndmask_b32 v15, 1.0, v112, s[48:49]
  v_cndmask_b32 v16, 0, v113, s[48:49]
  v_and_b32 v53, 64, v0
  v_cmp_ne_u32 s[48:49], 0, v53
  v_mul_f32 v114, v14, v14
  v_mul_f32 v115, v13, v14
  v_fma_f32 v114, v13, v13, -v114
  v_mfma_f32_32x32x16_bf16 v[188:203], a[200:203], a[40:43], v[188:203]
  buffer_load_dwordx4 v20, s[4:7], s70 offen offset:3072 lds
  v_add_f32 v115, v115, v115
  v_cndmask_b32 v11, 1.0, v11, s[48:49]
  v_cndmask_b32 v12, 0, v12, s[48:49]
  v_lshrrev_b32 v53, 7, v0
  v_cmp_ne_u32 s[48:49], 0, v53
  v_mul_f32 v116, v16, v12
  v_mul_f32_e64 v117, v15, v12
  v_fma_f32 v116, v15, v11, -v116
  v_fma_f32 v117, v16, v11, v117
  v_cndmask_b32 v13, 1.0, v13, s[48:49]
  v_cndmask_b32 v14, 0, v14, s[48:49]
  s_waitcnt vmcnt(11)
  s_barrier
  s_cmp_eq_u32 s72, 2
  s_cbranch_scc1 L_xb2
L_xr2:
  v_mfma_f32_32x32x16_bf16 v[204:219], a[204:207], a[40:43], v[204:219]
  ds_read_b128 a[68:71], v57 offset:32768
  ds_read_b128 a[72:75], v58 offset:32768
  ds_read_b128 a[164:167], v61 offset:16384
  ds_read_b128 a[76:79], v59 offset:32768
  ds_read_b128 a[80:83], v60 offset:32768
  ds_read_b128 a[168:171], v61 offset:20480
  v_mul_f32 v118, v117, v14
  v_mul_f32 v119, v116, v14
  v_fma_f32 v118, v116, v13, -v118
  v_fma_f32 v119, v117, v13, v119
  v_mul_f32 v11, v119, v119
  v_mul_f32 v12, v118, v119
  v_mfma_f32_32x32x16_bf16 v[220:235], a[208:211], a[40:43], v[220:235]
  ds_read_b128 a[172:175], v62 offset:16384
  s_add_u32 m0, s66, 147456
  ds_read_b128 a[176:179], v62 offset:20480
  buffer_load_dwordx4 v21, s[8:11], s70 offen lds
  v_fma_f32 v11, v118, v118, -v11
  v_add_f32 v12, v12, v12
  v_mul_f32 v13, v12, v12
  v_mul_f32 v14, v11, v12
  v_fma_f32 v13, v11, v11, -v13
  v_add_f32 v14, v14, v14
  v_mul_f32 v11, v14, v14
  v_mul_f32 v12, v13, v14
  s_waitcnt lgkmcnt(5)
  v_mfma_f32_32x32x16_bf16 v[140:155], a[68:71], a[164:167], v[140:155]
  ds_read_b128 a[180:183], v63 offset:16384
  s_add_u32 m0, s66, 151552
  ds_read_b128 a[184:187], v63 offset:20480
  buffer_load_dwordx4 v21, s[12:15], s70 offen lds
  v_fma_f32 v11, v13, v13, -v11
  v_add_f32 v12, v12, v12
  v_mul_f32 v116, v12, v12
  v_mul_f32 v117, v11, v12
  v_fma_f32 v116, v11, v11, -v116
  v_add_f32 v117, v117, v117
  s_xor_b32 s73, s62, 3
  v_xor_b32 v11, s73, v27
  s_waitcnt lgkmcnt(4)
  v_mfma_f32_32x32x16_bf16 v[156:171], a[68:71], a[168:171], v[156:171]
  ds_read_b128 a[188:191], v64 offset:16384
  ds_read_b128 a[192:195], v64 offset:20480
  s_add_u32 m0, s67, 16384
  s_mov_b32 s70, 229376
  buffer_load_dwordx4 v22, s[16:19], s70 offen offset:0 lds
  v_and_b32 v12, 3, v1
  v_lshlrev_b32 v12, 4, v12
  v_lshl_add_u32 v11, v11, 6, v12
  v_lshrrev_b32 v12, 4, v1
  v_lshl_add_u32 v11, v12, 10, v11
  s_lshl_b32 s73, s63, 8
  s_add_u32 s73, s73, s67
  s_waitcnt lgkmcnt(5)
  v_mfma_f32_32x32x16_bf16 v[140:155], a[72:75], a[172:175], v[140:155]
  ds_read_b64_tr_b16 a[196:197], v92 offset:0
  ds_read_b64_tr_b16 a[198:199], v92 offset:1024
  ds_read_b64_tr_b16 a[200:201], v93 offset:0
  ds_read_b64_tr_b16 a[202:203], v93 offset:1024
  buffer_load_dwordx4 v23, s[16:19], s70 offen offset:1024 lds
  v_add_u32 v135, s73, v11
  s_lshr_b32 s73, s61, 1
  s_xor_b32 s74, s73, 1
  s_mul_i32 s73, s73, 229376
  s_mul_i32 s74, s74, 229376
  s_lshl_b32 s80, s65, 17
  s_xor_b32 s81, s80, 131072
  s_waitcnt lgkmcnt(8)
  v_mfma_f32_32x32x16_bf16 v[156:171], a[72:75], a[176:179], v[156:171]
  ds_read_b64_tr_b16 a[204:205], v94 offset:0
  ds_read_b64_tr_b16 a[206:207], v94 offset:1024
  s_waitcnt lgkmcnt(6)
  s_lshl_b32 s84, s65, 14
  s_add_u32 s84, s84, 98304
  s_xor_b32 s85, s84, 16384
  s_add_u32 s78, s80, s73
  s_add_u32 s79, s81, s73
  s_add_u32 s80, s80, s74
  s_add_u32 s81, s81, s74
  s_add_u32 s82, s84, s73
  s_add_u32 s83, s85, s73
  v_mfma_f32_32x32x16_bf16 v[140:155], a[76:79], a[180:183], v[140:155]
  ds_read_b64_tr_b16 a[208:209], v95 offset:0
  ds_read_b64_tr_b16 a[210:211], v95 offset:1024
  buffer_load_dwordx4 v24, s[16:19], s70 offen offset:2048 lds
  s_add_u32 s84, s84, s74
  s_add_u32 s85, s85, s74
  s_lshl2_add_u32 s73, s60, s64
  s_mul_i32 s74, s73, 180224
  v_lshl_add_u32 v51, v1, 4, s74
  v_and_b32 v11, 1, v1
  v_lshlrev_b32 v11, 4, v11
  v_mov_b32 v13, 0x3f80
  v_lshlrev_b32 v11, v11, v13
  s_waitcnt vmcnt(9)
  s_barrier
  s_cmp_eq_u32 s72, 3
  s_cbranch_scc1 L_xb3
L_xr3:
  v_mfma_f32_32x32x16_bf16 v[156:171], a[76:79], a[184:187], v[156:171]
  ds_read_b128 a[84:87], v57 offset:0
  ds_read_b128 a[88:91], v58 offset:0
  ds_read_b128 a[164:167], v61 offset:24576
  buffer_load_dwordx4 v25, s[16:19], s70 offen offset:3072 lds
  v_lshlrev_b32 v14, 2, v3
  v_sub_u32 v14, v2, v14
  v_and_b32 v14, -2, v14
  v_cmp_eq_u32 s[48:49], 0, v14
  s_nop 1
  v_cndmask_b32 v12, 0, v11, s[48:49]
  v_cmp_eq_u32 s[48:49], 2, v14
  v_accvgpr_write_b32 a12, v12
  s_nop 0
  v_cndmask_b32 v12, 0, v11, s[48:49]
  v_mfma_f32_32x32x16_bf16 v[140:155], a[80:83], a[188:191], v[140:155]
  ds_read_b128 a[92:95], v59 offset:0
  ds_read_b128 a[96:99], v60 offset:0
  ds_read_b128 a[168:171], v61 offset:28672
  s_add_u32 m0, s67, 98304
  s_movk_i32 s70, 640
  buffer_load_dwordx4 v17, s[4:7], s70 offen offset:0 lds
  v_cmp_eq_u32 s[48:49], 8, v14
  v_accvgpr_write_b32 a13, v12
  s_nop 0
  v_cndmask_b32 v12, 0, v11, s[48:49]
  v_cmp_eq_u32 s[48:49], 10, v14
  v_accvgpr_write_b32 a14, v12
  s_nop 0
  v_cndmask_b32 v12, 0, v11, s[48:49]
  v_mfma_f32_32x32x16_bf16 v[156:171], a[80:83], a[192:195], v[156:171]
  ds_read_b128 a[172:175], v62 offset:24576
  s_waitcnt lgkmcnt(7)
  buffer_load_dwordx4 v18, s[4:7], s70 offen offset:1024 lds
  v_cmp_eq_u32 s[48:49], 16, v14
  v_accvgpr_write_b32 a15, v12
  s_nop 0
  v_cndmask_b32 v12, 0, v11, s[48:49]
  v_cmp_eq_u32 s[48:49], 18, v14
  v_accvgpr_write_b32 a16, v12
  s_nop 0
  v_cndmask_b32 v12, 0, v11, s[48:49]
  v_cmp_eq_u32 s[48:49], 24, v14
  v_accvgpr_write_b32 a17, v12
  s_nop 0
  v_cndmask_b32 v12, 0, v11, s[48:49]
  v_mfma_f32_32x32x16_bf16 v[172:187], a[196:199], a[44:47], v[172:187]
  ds_read_b128 a[176:179], v62 offset:28672
  v_cmp_eq_u32 s[48:49], 26, v14
  v_accvgpr_write_b32 a18, v12
  s_nop 0
  v_cndmask_b32 v12, 0, v11, s[48:49]
  v_accvgpr_write_b32 a19, v12
  v_mfma_f32_32x32x16_bf16 v[188:203], a[200:203], a[44:47], v[188:203]
  ds_read_b128 a[180:183], v63 offset:24576
  buffer_load_dwordx4 v19, s[4:7], s70 offen offset:2048 lds
  v_mfma_f32_32x32x16_bf16 v[204:219], a[204:207], a[44:47], v[204:219]
  ds_read_b128 a[184:187], v63 offset:28672
  v_mfma_f32_32x32x16_bf16 v[220:235], a[208:211], a[44:47], v[220:235]
  ds_read_b128 a[188:191], v64 offset:24576
  s_waitcnt lgkmcnt(3)
  v_mfma_f32_32x32x16_bf16 v[140:155], a[84:87], a[164:167], v[140:155]
  ds_read_b128 a[192:195], v64 offset:28672
  buffer_load_dwordx4 v20, s[4:7], s70 offen offset:3072 lds
  v_mfma_f32_32x32x16_bf16 v[156:171], a[84:87], a[168:171], v[156:171]
  ds_read_b64_tr_b16 a[196:197], v96 offset:0
  ds_read_b64_tr_b16 a[198:199], v96 offset:1024
  v_mfma_f32_32x32x16_bf16 v[140:155], a[88:91], a[172:175], v[140:155]
  ds_read_b64_tr_b16 a[200:201], v97 offset:0
  s_add_u32 m0, s66, 114688
  ds_read_b64_tr_b16 a[202:203], v97 offset:1024
  buffer_load_dwordx4 v21, s[8:11], s70 offen lds
  v_mfma_f32_32x32x16_bf16 v[156:171], a[88:91], a[176:179], v[156:171]
  ds_read_b64_tr_b16 a[204:205], v98 offset:0
  ds_read_b64_tr_b16 a[206:207], v98 offset:1024
  s_waitcnt lgkmcnt(6)
  v_mfma_f32_32x32x16_bf16 v[140:155], a[92:95], a[180:183], v[140:155]
  ds_read_b64_tr_b16 a[208:209], v99 offset:0
  ds_read_b64_tr_b16 a[210:211], v99 offset:1024
  buffer_load_dwordx4 v[28:31], v44, s[32:35], 0 offen sc1
  buffer_load_dwordx4 v[32:35], v49, s[32:35], 0 offen sc1
  s_waitcnt vmcnt(11)
  s_barrier
  s_cmp_eq_u32 s72, 4
  s_cbranch_scc1 L_xb4
L_xr4:
  v_mfma_f32_32x32x16_bf16 v[156:171], a[92:95], a[184:187], v[156:171]
  ds_read_b128 a[100:103], v57 offset:16384
  ds_read_b128 a[104:107], v58 offset:16384
  ds_read_b128 a[164:167], v61 offset:32768
  v_mfma_f32_32x32x16_bf16 v[140:155], a[96:99], a[188:191], v[140:155]
  ds_read_b128 a[108:111], v59 offset:16384
  ds_read_b128 a[112:115], v60 offset:16384
  ds_read_b128 a[168:171], v61 offset:36864
  v_mfma_f32_32x32x16_bf16 v[156:171], a[96:99], a[192:195], v[156:171]
  ds_read_b128 a[172:175], v62 offset:32768
  s_waitcnt lgkmcnt(7)
  v_mfma_f32_32x32x16_bf16 v[172:187], a[196:199], a[48:51], v[172:187]
  ds_read_b128 a[176:179], v62 offset:36864
  v_mfma_f32_32x32x16_bf16 v[188:203], a[200:203], a[48:51], v[188:203]
  s_add_u32 m0, s66, 118784
  ds_read_b128 a[180:183], v63 offset:32768
  buffer_load_dwordx4 v21, s[12:15], s70 offen lds
  v_mfma_f32_32x32x16_bf16 v[204:219], a[204:207], a[48:51], v[204:219]
  ds_read_b128 a[184:187], v63 offset:36864
  v_mfma_f32_32x32x16_bf16 v[220:235], a[208:211], a[48:51], v[220:235]
  ds_read_b128 a[188:191], v64 offset:32768
  s_waitcnt lgkmcnt(3)
  v_mfma_f32_32x32x16_bf16 v[140:155], a[100:103], a[164:167], v[140:155]
  ds_read_b128 a[192:195], v64 offset:36864
  s_add_u32 m0, s67, 65536
  s_movk_i32 s70, 768
  buffer_load_dwordx4 v17, s[4:7], s70 offen offset:0 lds
  s_waitcnt vmcnt(9)
  s_barrier
  v_mfma_f32_32x32x16_bf16 v[156:171], a[100:103], a[168:171], v[156:171]
  ds_read_b64_tr_b16 a[196:197], v84 offset:16384
  ds_read_b64_tr_b16 a[198:199], v84 offset:17408
  v_mfma_f32_32x32x16_bf16 v[140:155], a[104:107], a[172:175], v[140:155]
  ds_read_b64_tr_b16 a[200:201], v85 offset:16384
  ds_read_b64_tr_b16 a[202:203], v85 offset:17408
  v_mfma_f32_32x32x16_bf16 v[156:171], a[104:107], a[176:179], v[156:171]
  ds_read_b64_tr_b16 a[204:205], v86 offset:16384
  ds_read_b64_tr_b16 a[206:207], v86 offset:17408
  s_waitcnt lgkmcnt(6)
  buffer_load_dwordx4 v18, s[4:7], s70 offen offset:1024 lds
  v_mfma_f32_32x32x16_bf16 v[140:155], a[108:111], a[180:183], v[140:155]
  ds_read_b64_tr_b16 a[208:209], v87 offset:16384
  ds_read_b64_tr_b16 a[210:211], v87 offset:17408
  buffer_load_dwordx4 v19, s[4:7], s70 offen offset:2048 lds
  buffer_load_dwordx4 v20, s[4:7], s70 offen offset:3072 lds
  s_add_u32 m0, s66, 122880
  s_nop 0
  buffer_load_dwordx4 v21, s[8:11], s70 offen lds
  s_waitcnt vmcnt(5)
  s_barrier
  s_cmp_eq_u32 s72, 5
  s_cbranch_scc1 L_xb5
L_xr5:
  v_mfma_f32_32x32x16_bf16 v[156:171], a[108:111], a[184:187], v[156:171]
  ds_read_b128 a[116:119], v57 offset:32768
  ds_read_b128 a[120:123], v58 offset:32768
  s_add_u32 m0, s66, 126976
  ds_read_b128 a[164:167], v61 offset:0
  buffer_load_dwordx4 v21, s[12:15], s70 offen lds
  v_xor_b32 v4, v29, v66
  v_bitop3_b32 v4, v4, v31, v67 bitop3:0xf6
  v_bitop3_b32 v4, v4, v33, v66 bitop3:0xf6
  v_bitop3_b32 v4, v4, v35, v67 bitop3:0xf6
  v_cmp_ne_u32 vcc, 0, v4
  s_cbranch_vccnz L_sp2
L_ok2:
  v_mfma_f32_32x32x16_bf16 v[140:155], a[112:115], a[188:191], v[140:155]
  ds_read_b128 a[124:127], v59 offset:32768
  ds_read_b128 a[128:131], v60 offset:32768
  ds_read_b128 a[168:171], v61 offset:4096
  s_add_u32 m0, s67, 81920
  s_movk_i32 s70, 896
  buffer_load_dwordx4 v17, s[4:7], s70 offen offset:0 lds
  v_mfma_f32_32x32x16_bf16 v[156:171], a[112:115], a[192:195], v[156:171]
  ds_read_b128 a[172:175], v62 offset:0
  s_waitcnt lgkmcnt(7)
  buffer_load_dwordx4 v18, s[4:7], s70 offen offset:1024 lds
  v_and_b32 v237, 0xffff0000, v28
  v_mfma_f32_32x32x16_bf16 v[172:187], a[196:199], a[52:55], v[172:187]
  ds_read_b128 a[176:179], v62 offset:4096
  buffer_load_dwordx4 v19, s[4:7], s70 offen offset:2048 lds
  v_rcp_f32 v139, v237
  v_mov_b32 v68, v32
  v_mfma_f32_16x16x32_bf16 a[20:23], a[0:3], a[196:199], a[20:23]
  buffer_load_dwordx4 v20, s[4:7], s70 offen offset:3072 lds
  v_mov_b32 v70, v32
  v_mfma_f32_32x32x16_bf16 v[188:203], a[200:203], a[52:55], v[188:203]
  ds_read_b128 a[180:183], v63 offset:0
  v_lshlrev_b32 v138, 16, v28
  v_cmp_eq_u32 vcc, 0, v3
  v_and_b32 v5, 0xffff0000, v30
  v_lshlrev_b32 v6, 16, v30
  v_mfma_f32_16x16x32_bf16 a[24:27], a[0:3], a[200:203], a[24:27]
  v_permlane32_swap_b32 v68, v70
  ds_write_b32 v126, v139
  v_mfma_f32_32x32x16_bf16 v[204:219], a[204:207], a[52:55], v[204:219]
  s_add_u32 m0, s66, 131072
  ds_read_b128 a[184:187], v63 offset:4096
  buffer_load_dwordx4 v21, s[8:11], s70 offen lds
  ds_read_b128 v[28:31], v127 offset:0
  ds_read_b128 v[32:35], v127 offset:16
  v_mfma_f32_16x16x32_bf16 a[28:31], a[0:3], a[204:207], a[28:31]
  ds_read_b128 v[36:39], v127 offset:32
  ds_read_b128 v[40:43], v127 offset:48
  v_mfma_f32_32x32x16_bf16 v[220:235], a[208:211], a[52:55], v[220:235]
  ds_read_b128 a[188:191], v64 offset:0
  v_mul_f32 v236, v237, v5
  v_rcp_f32 v7, v236
  v_fma_f32 v6, v6, v237, v138
  v_mfma_f32_16x16x32_bf16 a[32:35], a[0:3], a[208:211], a[32:35]
  s_add_u32 m0, s66, 135168
  s_waitcnt lgkmcnt(8)
  buffer_load_dwordx4 v21, s[12:15], s70 offen lds
  v_mfma_f32_32x32x16_bf16 v[140:155], a[116:119], a[164:167], v[140:155]
  ds_read_b128 a[192:195], v64 offset:4096
  v_cndmask_b32 v4, 0, v138, vcc
  v_cvt_pk_bf16_f32 v130, -v4, -v4
  v_mov_b32 v131, 0
  v_and_b32 v4, 0xffff0000, v6
  v_mfma_f32_32x32x16_bf16 v[156:171], a[116:119], a[168:171], v[156:171]
  ds_read_b64_tr_b16 a[196:197], v88 offset:16384
  ds_read_b64_tr_b16 a[198:199], v88 offset:17408
  s_add_u32 m0, s67, 32768
  s_mov_b32 s70, 458752
  buffer_load_dwordx4 v22, s[16:19], s70 offen offset:0 lds
  v_mfma_f32_32x32x16_bf16 v[140:155], a[120:123], a[172:175], v[140:155]
  ds_read_b64_tr_b16 a[200:201], v89 offset:16384
  ds_read_b64_tr_b16 a[202:203], v89 offset:17408
  v_sub_f32 v5, v6, v4
  v_cndmask_b32 v4, v5, v4, vcc
  v_cvt_pk_bf16_f32 v240, -v4, -v4
  v_mfma_f32_32x32x16_bf16 v[156:171], a[120:123], a[176:179], v[156:171]
  ds_read_b64_tr_b16 a[204:205], v90 offset:16384
  ds_read_b64_tr_b16 a[206:207], v90 offset:17408
  s_waitcnt lgkmcnt(6)
  v_and_b32 v4, 0xffff0000, v236
  v_sub_f32 v5, v236, v4
  v_mfma_f32_32x32x16_bf16 v[140:155], a[124:127], a[180:183], v[140:155]
  ds_read_b64_tr_b16 a[208:209], v91 offset:16384
  ds_read_b64_tr_b16 a[210:211], v91 offset:17408
  v_cndmask_b32 v4, v5, v4, vcc
  v_cvt_pk_bf16_f32 v241, v4, 0
  v_mul_f32 v238, 0xc0135761, v7
  s_waitcnt vmcnt(7)
  s_barrier
  s_cmp_eq_u32 s72, 6
  s_cbranch_scc1 L_xb6
L_xr6:
  v_mfma_f32_32x32x16_bf16 v[156:171], a[124:127], a[184:187], v[156:171]
  ds_read_b128 a[132:135], v57 offset:0
  ds_read_b128 a[136:139], v58 offset:0
  ds_read_b128 a[164:167], v61 offset:8192
  buffer_load_dwordx4 v23, s[16:19], s70 offen offset:1024 lds
  v_mul_f32 v7, v7, v7
  v_mfma_f32_32x32x16_bf16 v[140:155], a[128:131], a[188:191], v[140:155]
  ds_read_b128 a[140:143], v59 offset:0
  ds_read_b128 a[144:147], v60 offset:0
  ds_read_b128 a[168:171], v61 offset:12288
  v_mul_f32 v7, 0x3d372713, v7
  v_mul_f32 v239, v238, v7
  v_mfma_f32_32x32x16_bf16 v[156:171], a[128:131], a[192:195], v[156:171]
  ds_read_b128 a[172:175], v62 offset:8192
  s_waitcnt lgkmcnt(7)
  buffer_load_dwordx4 v24, s[16:19], s70 offen offset:2048 lds
  v_mfma_f32_32x32x16_bf16 v[172:187], a[196:199], a[56:59], v[172:187]
  ds_read_b128 a[176:179], v62 offset:12288
  v_mfma_f32_32x32x16_bf16 v[188:203], a[200:203], a[56:59], v[188:203]
  ds_read_b128 a[180:183], v63 offset:8192
  buffer_load_dwordx4 v25, s[16:19], s70 offen offset:3072 lds
  v_mfma_f32_32x32x16_bf16 v[204:219], a[204:207], a[56:59], v[204:219]
  ds_read_b128 a[184:187], v63 offset:12288
  v_mfma_f32_32x32x16_bf16 v[220:235], a[208:211], a[56:59], v[220:235]
  ds_read_b128 a[188:191], v64 offset:8192
  s_waitcnt lgkmcnt(3)
  v_mfma_f32_32x32x16_bf16 v[140:155], a[132:135], a[164:167], v[140:155]
  ds_read_b128 a[192:195], v64 offset:12288
  s_add_u32 m0, s67, 49152
  s_mov_b32 s70, 688128
  buffer_load_dwordx4 v22, s[16:19], s70 offen offset:0 lds
  v_mfma_f32_32x32x16_bf16 v[156:171], a[132:135], a[168:171], v[156:171]
  ds_read_b64_tr_b16 a[196:197], v92 offset:16384
  ds_read_b64_tr_b16 a[198:199], v92 offset:17408
  v_mfma_f32_32x32x16_bf16 v[140:155], a[136:139], a[172:175], v[140:155]
  ds_read_b64_tr_b16 a[200:201], v93 offset:16384
  ds_read_b64_tr_b16 a[202:203], v93 offset:17408
  buffer_load_dwordx4 v23, s[16:19], s70 offen offset:1024 lds
  v_mfma_f32_32x32x16_bf16 v[156:171], a[136:139], a[176:179], v[156:171]
  ds_read_b64_tr_b16 a[204:205], v94 offset:16384
  ds_read_b64_tr_b16 a[206:207], v94 offset:17408
  s_waitcnt lgkmcnt(6)
  v_mfma_f32_32x32x16_bf16 v[140:155], a[140:143], a[180:183], v[140:155]
  ds_read_b64_tr_b16 a[208:209], v95 offset:16384
  ds_read_b64_tr_b16 a[210:211], v95 offset:17408
  buffer_load_dwordx4 v24, s[16:19], s70 offen offset:2048 lds
  buffer_load_dwordx4 v25, s[16:19], s70 offen offset:3072 lds
  s_add_u32 m0, s67, 0
  s_mov_b32 s70, 917504
  buffer_load_dwordx4 v22, s[16:19], s70 offen offset:0 lds
  s_waitcnt vmcnt(9)
  s_barrier
  s_cmp_eq_u32 s72, 7
  s_cbranch_scc1 L_xb7
L_xr7:
  v_mfma_f32_32x32x16_bf16 v[156:171], a[140:143], a[184:187], v[156:171]
  ds_read_b128 a[148:151], v57 offset:16384
  ds_read_b128 a[152:155], v58 offset:16384
  ds_read_b128 a[164:167], v61 offset:16384
  global_load_dword v47, v46, s[90:91]
  v_mfma_f32_32x32x16_bf16 v[140:155], a[144:147], a[188:191], v[140:155]
  ds_read_b128 a[156:159], v59 offset:16384
  ds_read_b128 a[160:163], v60 offset:16384
  ds_read_b128 a[168:171], v61 offset:20480
  buffer_load_dword v47, v50, s[32:35], 0 offen
  v_mfma_f32_32x32x16_bf16 v[156:171], a[144:147], a[192:195], v[156:171]
  ds_read_b128 a[172:175], v62 offset:16384
  s_waitcnt lgkmcnt(7)
  v_mfma_f32_32x32x16_bf16 v[172:187], a[196:199], a[60:63], v[172:187]
  ds_read_b128 a[176:179], v62 offset:20480
  global_load_ushort v73, v77, s[56:57]
  v_mfma_f32_32x32x16_bf16 v[188:203], a[200:203], a[60:63], v[188:203]
  ds_read_b128 a[180:183], v63 offset:16384
  v_mfma_f32_32x32x16_bf16 v[204:219], a[204:207], a[60:63], v[204:219]
  ds_read_b128 a[184:187], v63 offset:20480
  global_load_ushort v75, v77, s[56:57] offset:64
  v_mfma_f32_32x32x16_bf16 v[220:235], a[208:211], a[60:63], v[220:235]
  ds_read_b128 a[188:191], v64 offset:16384
  s_waitcnt lgkmcnt(3)
  v_mfma_f32_32x32x16_bf16 v[140:155], a[148:151], a[164:167], v[140:155]
  ds_read_b128 a[192:195], v64 offset:20480
  global_load_ushort v77, v77, s[56:57] offset:128
  v_mfma_f32_32x32x16_bf16 v[156:171], a[148:151], a[168:171], v[156:171]
  ds_read_b64_tr_b16 a[196:197], v96 offset:16384
  ds_read_b64_tr_b16 a[198:199], v96 offset:17408
  v_mfma_f32_32x32x16_bf16 v[140:155], a[152:155], a[172:175], v[140:155]
  ds_read_b64_tr_b16 a[200:201], v97 offset:16384
  ds_read_b64_tr_b16 a[202:203], v97 offset:17408
  global_load_ushort v79, v79, s[56:57]
  v_mfma_f32_32x32x16_bf16 v[156:171], a[152:155], a[176:179], v[156:171]
  ds_read_b64_tr_b16 a[204:205], v98 offset:16384
  ds_read_b64_tr_b16 a[206:207], v98 offset:17408
  s_waitcnt lgkmcnt(6)
  global_load_ushort v54, v80, s[54:55]
  v_mfma_f32_32x32x16_bf16 v[140:155], a[156:159], a[180:183], v[140:155]
  ds_read_b64_tr_b16 a[208:209], v99 offset:16384
  ds_read_b64_tr_b16 a[210:211], v99 offset:17408
  s_waitcnt vmcnt(12)
  s_barrier
  v_mfma_f32_32x32x16_bf16 v[156:171], a[156:159], a[184:187], v[156:171]
  ds_read_b64_tr_b16 a[164:165], v84 offset:32768
  ds_read_b64_tr_b16 a[166:167], v84 offset:33792
  global_load_ushort v80, v80, s[58:59]
  v_mfma_f32_32x32x16_bf16 v[140:155], a[160:163], a[188:191], v[140:155]
  ds_read_b64_tr_b16 a[168:169], v85 offset:32768
  ds_read_b64_tr_b16 a[170:171], v85 offset:33792
  v_mfma_f32_32x32x16_bf16 v[156:171], a[160:163], a[192:195], v[156:171]
  ds_read_b64_tr_b16 a[172:173], v86 offset:32768
  ds_read_b64_tr_b16 a[174:175], v86 offset:33792
  buffer_load_dwordx4 v23, s[16:19], s70 offen offset:1024 lds
  s_waitcnt lgkmcnt(6)
  v_mfma_f32_32x32x16_bf16 v[172:187], a[196:199], a[64:67], v[172:187]
  ds_read_b64_tr_b16 a[176:177], v87 offset:32768
  ds_read_b64_tr_b16 a[178:179], v87 offset:33792
  s_add_u32 s12, s32, s92
  s_addc_u32 s13, s33, 0
  v_mfma_f32_32x32x8_bf16 v[140:155], v[130:131], v[68:69], v[140:155]
  v_mfma_f32_32x32x8_bf16 v[156:171], v[130:131], v[70:71], v[156:171]
  v_mfma_f32_32x32x16_bf16 v[188:203], a[200:203], a[64:67], v[188:203]
  ds_read_b64_tr_b16 a[180:181], v88 offset:32768
  ds_read_b64_tr_b16 a[182:183], v88 offset:33792
  buffer_load_dwordx4 v24, s[16:19], s70 offen offset:2048 lds
  s_add_u32 s14, s32, s93
  s_addc_u32 s15, s33, 0
  s_nop 4
  v_pk_mul_f32 v[140:141], v[140:141], v[28:29]
  v_pk_mul_f32 v[156:157], v[156:157], v[28:29] neg_lo:[0,1] neg_hi:[0,1]
  v_pk_mul_f32 v[142:143], v[142:143], v[30:31]
  v_pk_mul_f32 v[158:159], v[158:159], v[30:31] neg_lo:[0,1] neg_hi:[0,1]
  v_pk_mul_f32 v[144:145], v[144:145], v[32:33]
  v_pk_mul_f32 v[160:161], v[160:161], v[32:33] neg_lo:[0,1] neg_hi:[0,1]
  v_pk_mul_f32 v[146:147], v[146:147], v[34:35]
  v_pk_mul_f32 v[162:163], v[162:163], v[34:35] neg_lo:[0,1] neg_hi:[0,1]
  v_pk_mul_f32 v[148:149], v[148:149], v[36:37]
  v_pk_mul_f32 v[164:165], v[164:165], v[36:37] neg_lo:[0,1] neg_hi:[0,1]
  v_pk_mul_f32 v[150:151], v[150:151], v[38:39]
  v_pk_mul_f32 v[166:167], v[166:167], v[38:39] neg_lo:[0,1] neg_hi:[0,1]
  v_pk_mul_f32 v[152:153], v[152:153], v[40:41]
  v_pk_mul_f32 v[168:169], v[168:169], v[40:41] neg_lo:[0,1] neg_hi:[0,1]
  v_pk_mul_f32 v[154:155], v[154:155], v[42:43]
  v_pk_mul_f32 v[170:171], v[170:171], v[42:43] neg_lo:[0,1] neg_hi:[0,1]
  v_pk_fma_f32 v[244:245], v[140:141], v[108:109], v[142:143] op_sel:[0,0,0] op_sel_hi:[1,0,1]
  v_pk_fma_f32 v[246:247], v[156:157], v[108:109], v[158:159] op_sel:[0,0,0] op_sel_hi:[1,0,1]
  v_pk_fma_f32 v[244:245], v[156:157], v[108:109], v[244:245] op_sel:[0,1,0] op_sel_hi:[1,1,1] neg_lo:[0,1,0] neg_hi:[0,1,0]
  v_pk_fma_f32 v[246:247], v[140:141], v[108:109], v[246:247] op_sel:[0,1,0] op_sel_hi:[1,1,1]
  v_pk_fma_f32 v[248:249], v[244:245], v[108:109], v[144:145] op_sel:[0,0,0] op_sel_hi:[1,0,1]
  v_pk_fma_f32 v[250:251], v[246:247], v[108:109], v[160:161] op_sel:[0,0,0] op_sel_hi:[1,0,1]
  v_pk_fma_f32 v[248:249], v[246:247], v[108:109], v[248:249] op_sel:[0,1,0] op_sel_hi:[1,1,1] neg_lo:[0,1,0] neg_hi:[0,1,0]
  v_pk_fma_f32 v[250:251], v[244:245], v[108:109], v[250:251] op_sel:[0,1,0] op_sel_hi:[1,1,1]
  v_pk_fma_f32 v[244:245], v[248:249], v[108:109], v[146:147] op_sel:[0,0,0] op_sel_hi:[1,0,1]
  v_pk_fma_f32 v[246:247], v[250:251], v[108:109], v[162:163] op_sel:[0,0,0] op_sel_hi:[1,0,1]
  v_pk_fma_f32 v[244:245], v[250:251], v[108:109], v[244:245] op_sel:[0,1,0] op_sel_hi:[1,1,1] neg_lo:[0,1,0] neg_hi:[0,1,0]
  v_pk_fma_f32 v[246:247], v[248:249], v[108:109], v[246:247] op_sel:[0,1,0] op_sel_hi:[1,1,1]
  v_pk_fma_f32 v[248:249], v[244:245], v[108:109], v[148:149] op_sel:[0,0,0] op_sel_hi:[1,0,1]
  v_pk_fma_f32 v[250:251], v[246:247], v[108:109], v[164:165] op_sel:[0,0,0] op_sel_hi:[1,0,1]
  v_pk_fma_f32 v[248:249], v[246:247], v[108:109], v[248:249] op_sel:[0,1,0] op_sel_hi:[1,1,1] neg_lo:[0,1,0] neg_hi:[0,1,0]
  v_pk_fma_f32 v[250:251], v[244:245], v[108:109], v[250:251] op_sel:[0,1,0] op_sel_hi:[1,1,1]
  v_pk_fma_f32 v[244:245], v[248:249], v[108:109], v[150:151] op_sel:[0,0,0] op_sel_hi:[1,0,1]
  v_pk_fma_f32 v[246:247], v[250:251], v[108:109], v[166:167] op_sel:[0,0,0] op_sel_hi:[1,0,1]
  v_pk_fma_f32 v[244:245], v[250:251], v[108:109], v[244:245] op_sel:[0,1,0] op_sel_hi:[1,1,1] neg_lo:[0,1,0] neg_hi:[0,1,0]
  v_pk_fma_f32 v[246:247], v[248:249], v[108:109], v[246:247] op_sel:[0,1,0] op_sel_hi:[1,1,1]
  v_pk_fma_f32 v[248:249], v[244:245], v[108:109], v[152:153] op_sel:[0,0,0] op_sel_hi:[1,0,1]
  v_pk_fma_f32 v[250:251], v[246:247], v[108:109], v[168:169] op_sel:[0,0,0] op_sel_hi:[1,0,1]
  v_pk_fma_f32 v[248:249], v[246:247], v[108:109], v[248:249] op_sel:[0,1,0] op_sel_hi:[1,1,1] neg_lo:[0,1,0] neg_hi:[0,1,0]
  v_pk_fma_f32 v[250:251], v[244:245], v[108:109], v[250:251] op_sel:[0,1,0] op_sel_hi:[1,1,1]
  v_pk_fma_f32 v[244:245], v[248:249], v[108:109], v[154:155] op_sel:[0,0,0] op_sel_hi:[1,0,1]
  v_pk_fma_f32 v[246:247], v[250:251], v[108:109], v[170:171] op_sel:[0,0,0] op_sel_hi:[1,0,1]
  v_pk_fma_f32 v[244:245], v[250:251], v[108:109], v[244:245] op_sel:[0,1,0] op_sel_hi:[1,1,1] neg_lo:[0,1,0] neg_hi:[0,1,0]
  v_pk_fma_f32 v[246:247], v[248:249], v[108:109], v[246:247] op_sel:[0,1,0] op_sel_hi:[1,1,1]
  s_nop 1
  v_mfma_f32_32x32x16_bf16 v[204:219], a[204:207], a[64:67], v[204:219]
  ds_read_b64_tr_b16 a[184:185], v89 offset:32768
  ds_read_b64_tr_b16 a[186:187], v89 offset:33792
  buffer_load_dwordx4 v25, s[16:19], s70 offen offset:3072 lds
  v_fma_f32 v122, v244, v110, v245
  v_fma_f32 v123, v244, v111, v247
  v_fma_f32 v122, -v246, v111, v122
  v_fma_f32 v123, v246, v110, v123
  v_mfma_f32_32x32x16_bf16 v[220:235], a[208:211], a[64:67], v[220:235]
  ds_read_b64_tr_b16 a[188:189], v90 offset:32768
  ds_read_b64_tr_b16 a[190:191], v90 offset:33792
  s_waitcnt lgkmcnt(6)
  ds_write_b64 v132, v[122:123] offset:1792
  s_lshl_b32 s10, s62, 7
  v_mfma_f32_32x32x16_bf16 v[172:187], a[164:167], a[68:71], v[172:187]
  ds_read_b64_tr_b16 a[192:193], v91 offset:32768
  ds_read_b64_tr_b16 a[194:195], v91 offset:33792
  s_xor_b32 s8, s10, 384
  s_xor_b32 s9, s10, 272
  s_xor_b32 s10, s10, 152
  v_mfma_f32_16x16x32_bf16 a[20:23], a[0:3], a[164:167], a[20:23]
  s_waitcnt lgkmcnt(2)
  s_barrier
  ds_read2_b64 v[28:31], v132 offset0:0 offset1:32
  ds_read2_b64 v[32:35], v132 offset0:64 offset1:96
  v_mfma_f32_32x32x16_bf16 v[188:203], a[168:171], a[68:71], v[188:203]
  ds_read_b64_tr_b16 a[196:197], v92 offset:32768
  ds_read_b64_tr_b16 a[198:199], v92 offset:33792
  ds_read2_b64 v[36:39], v132 offset0:128 offset1:160
  ds_read_b64 v[40:41], v132 offset:1536
  v_mul_u32_u24 v4, 0xfffc00, v3
  v_bfe_i32 v4, v4, 0, 24
  v_mfma_f32_16x16x32_bf16 a[24:27], a[0:3], a[168:171], a[24:27]
  s_xor_b32 s44, s61, 1
  s_mulk_i32 s44, 11264
  v_mfma_f32_32x32x16_bf16 v[204:219], a[172:175], a[68:71], v[204:219]
  ds_read_b64_tr_b16 a[200:201], v93 offset:32768
  ds_read_b64_tr_b16 a[202:203], v93 offset:33792
  s_add_u32 m0, s67, 16384
  s_mov_b32 s70, 1146880
  buffer_load_dwordx4 v22, s[16:19], s70 offen offset:0 lds
  v_mfma_f32_16x16x32_bf16 a[28:31], a[0:3], a[172:175], a[28:31]
  s_waitcnt lgkmcnt(7)
  v_fma_f32 v30, v28, v112, v30
  v_fma_f32 v31, v28, v113, v31
  v_fma_f32 v30, -v29, v113, v30
  v_fma_f32 v31, v29, v112, v31
  v_mfma_f32_32x32x16_bf16 v[220:235], a[176:179], a[68:71], v[220:235]
  ds_read_b64_tr_b16 a[204:205], v94 offset:32768
  ds_read_b64_tr_b16 a[206:207], v94 offset:33792
  s_waitcnt lgkmcnt(8)
  v_fma_f32 v32, v30, v112, v32
  v_fma_f32 v33, v30, v113, v33
  v_fma_f32 v32, -v31, v113, v32
  v_fma_f32 v33, v31, v112, v33
  v_fma_f32 v34, v32, v112, v34
  v_mfma_f32_16x16x32_bf16 a[32:35], a[0:3], a[176:179], a[32:35]
  buffer_load_dwordx4 v23, s[16:19], s70 offen offset:1024 lds
  v_fma_f32 v35, v32, v113, v35
  v_fma_f32 v34, -v33, v113, v34
  v_mfma_f32_32x32x16_bf16 v[172:187], a[180:183], a[72:75], v[172:187]
  ds_read_b64_tr_b16 a[208:209], v95 offset:32768
  ds_read_b64_tr_b16 a[210:211], v95 offset:33792
  v_fma_f32 v35, v33, v112, v35
  s_waitcnt lgkmcnt(7)
  v_fma_f32 v36, v34, v112, v36
  v_fma_f32 v37, v34, v113, v37
  v_fma_f32 v36, -v35, v113, v36
  v_fma_f32 v37, v35, v112, v37
  v_mfma_f32_32x32x16_bf16 v[188:203], a[184:187], a[72:75], v[188:203]
  ds_read_b64_tr_b16 a[164:165], v96 offset:32768
  ds_read_b64_tr_b16 a[166:167], v96 offset:33792
  v_fma_f32 v38, v36, v112, v38
  v_fma_f32 v39, v36, v113, v39
  v_fma_f32 v38, -v37, v113, v38
  v_fma_f32 v39, v37, v112, v39
  s_waitcnt lgkmcnt(8)
  v_fma_f32 v128, v38, v112, v40
  v_mfma_f32_32x32x16_bf16 v[204:219], a[188:191], a[72:75], v[204:219]
  ds_read_b64_tr_b16 a[168:169], v97 offset:32768
  ds_read_b64_tr_b16 a[170:171], v97 offset:33792
  buffer_load_dwordx4 v24, s[16:19], s70 offen offset:2048 lds
  v_fma_f32 v129, v38, v113, v41
  v_fma_f32 v128, -v39, v113, v128
  v_fma_f32 v129, v39, v112, v129
  v_fma_f32 v122, v128, v112, v122
  v_mfma_f32_32x32x16_bf16 v[220:235], a[192:195], a[72:75], v[220:235]
  ds_read_b64_tr_b16 a[172:173], v98 offset:32768
  ds_read_b64_tr_b16 a[174:175], v98 offset:33792
  s_waitcnt lgkmcnt(6)
  v_fma_f32 v123, v128, v113, v123
  v_fma_f32 v122, -v129, v113, v122
  v_fma_f32 v123, v129, v112, v123
  v_and_or_b32 v122, v122, v4, v137
  v_mfma_f32_32x32x16_bf16 v[172:187], a[196:199], a[76:79], v[172:187]
  ds_read_b64_tr_b16 a[176:177], v99 offset:32768
  ds_read_b64_tr_b16 a[178:179], v99 offset:33792
  v_and_or_b32 v123, v123, v4, v137
  buffer_store_dwordx2 v[122:123], v124, s[40:43], 0 offen sc0 sc1
  v_mul_f32 v248, v121, v156
  s_waitcnt vmcnt(16)
  s_barrier
  v_mfma_f32_32x32x16_bf16 v[188:203], a[200:203], a[76:79], v[188:203]
  ds_read_b64_tr_b16 a[180:181], v84 offset:49152
  ds_read_b64_tr_b16 a[182:183], v84 offset:50176
  buffer_load_dwordx4 v25, s[16:19], s70 offen offset:3072 lds
  v_mul_f32 v156, v120, v156
  v_fmac_f32 v156, v121, v140
  v_mfma_f32_32x32x16_bf16 v[204:219], a[204:207], a[76:79], v[204:219]
  ds_read_b64_tr_b16 a[184:185], v85 offset:49152
  ds_read_b64_tr_b16 a[186:187], v85 offset:50176
  v_fma_f32 v140, v120, v140, -v248
  v_mul_f32 v249, v121, v157
  v_mul_f32 v157, v120, v157
  v_mfma_f32_32x32x16_bf16 v[220:235], a[208:211], a[76:79], v[220:235]
  ds_read_b64_tr_b16 a[188:189], v86 offset:49152
  ds_read_b64_tr_b16 a[190:191], v86 offset:50176
  s_waitcnt lgkmcnt(6)
  v_fmac_f32 v157, v121, v141
  v_fma_f32 v141, v120, v141, -v249
  v_mfma_f32_32x32x16_bf16 v[172:187], a[164:167], a[80:83], v[172:187]
  ds_read_b64_tr_b16 a[192:193], v87 offset:49152
  s_add_u32 m0, s66, 139264
  ds_read_b64_tr_b16 a[194:195], v87 offset:50176
  buffer_load_dwordx4 v136, s[24:27], s86 offen lds
  v_mul_f32 v248, v121, v158
  v_mfma_f32_32x32x16_bf16 v[188:203], a[168:171], a[80:83], v[188:203]
  ds_read_b64_tr_b16 a[196:197], v88 offset:49152
  ds_read_b64_tr_b16 a[198:199], v88 offset:50176
  v_mul_f32 v158, v120, v158
  v_fmac_f32 v158, v121, v142
  v_fma_f32 v142, v120, v142, -v248
  v_mfma_f32_32x32x16_bf16 v[204:219], a[172:175], a[80:83], v[204:219]
  ds_read_b64_tr_b16 a[200:201], v89 offset:49152
  ds_read_b64_tr_b16 a[202:203], v89 offset:50176
  v_mul_f32 v249, v121, v159
  v_mul_f32 v159, v120, v159
  v_fmac_f32 v159, v121, v143
  v_mfma_f32_32x32x16_bf16 v[220:235], a[176:179], a[80:83], v[220:235]
  ds_read_b64_tr_b16 a[204:205], v90 offset:49152
  ds_read_b64_tr_b16 a[206:207], v90 offset:50176
  s_add_u32 m0, s66, 143360
  s_waitcnt lgkmcnt(6)
  buffer_load_dwordx4 v136, s[24:27], s87 offen lds
  v_mfma_f32_32x32x16_bf16 v[172:187], a[180:183], a[84:87], v[172:187]
  ds_read_b64_tr_b16 a[208:209], v91 offset:49152
  ds_read_b64_tr_b16 a[210:211], v91 offset:50176
  v_fma_f32 v143, v120, v143, -v249
  v_mul_f32 v248, v121, v160
  v_mul_f32 v160, v120, v160
  v_mfma_f32_16x16x32_bf16 a[20:23], a[0:3], a[180:183], a[20:23]
  v_fmac_f32 v160, v121, v144
  v_fma_f32 v144, v120, v144, -v248
  v_mfma_f32_32x32x16_bf16 v[188:203], a[184:187], a[84:87], v[188:203]
  ds_read_b64_tr_b16 a[164:165], v92 offset:49152
  s_add_u32 m0, s66, 147456
  ds_read_b64_tr_b16 a[166:167], v92 offset:50176
  buffer_load_dwordx4 v136, s[24:27], s88 offen lds
  v_mul_f32 v249, v121, v161
  v_mfma_f32_16x16x32_bf16 a[24:27], a[0:3], a[184:187], a[24:27]
  v_mul_f32 v161, v120, v161
  v_fmac_f32 v161, v121, v145
  v_mfma_f32_32x32x16_bf16 v[204:219], a[188:191], a[84:87], v[204:219]
  ds_read_b64_tr_b16 a[168:169], v93 offset:49152
  ds_read_b64_tr_b16 a[170:171], v93 offset:50176
  v_fma_f32 v145, v120, v145, -v249
  v_mul_f32 v248, v121, v162
  v_mul_f32 v162, v120, v162
  s_add_u32 m0, s66, 151552
  v_mfma_f32_16x16x32_bf16 a[28:31], a[0:3], a[188:191], a[28:31]
  buffer_load_dwordx4 v136, s[28:31], s86 offen lds
  v_mfma_f32_32x32x16_bf16 v[220:235], a[192:195], a[84:87], v[220:235]
  ds_read_b64_tr_b16 a[172:173], v94 offset:49152
  ds_read_b64_tr_b16 a[174:175], v94 offset:50176
  v_fmac_f32 v162, v121, v146
  v_fma_f32 v146, v120, v146, -v248
  v_mul_f32 v249, v121, v163
  v_mfma_f32_16x16x32_bf16 a[32:35], a[0:3], a[192:195], a[32:35]
  s_waitcnt lgkmcnt(6)
  v_mul_f32 v163, v120, v163
  v_mfma_f32_32x32x16_bf16 v[172:187], a[196:199], a[88:91], v[172:187]
  ds_read_b64_tr_b16 a[176:177], v95 offset:49152
  ds_read_b64_tr_b16 a[178:179], v95 offset:50176
  v_fmac_f32 v163, v121, v147
  v_fma_f32 v147, v120, v147, -v249
  v_mul_f32 v248, v121, v164
  v_mfma_f32_32x32x16_bf16 v[188:203], a[200:203], a[88:91], v[188:203]
  ds_read_b64_tr_b16 a[180:181], v96 offset:49152
  s_add_u32 m0, s66, 98304
  ds_read_b64_tr_b16 a[182:183], v96 offset:50176
  buffer_load_dwordx4 v136, s[28:31], s87 offen lds
  v_mul_f32 v164, v120, v164
  v_mfma_f32_32x32x16_bf16 v[204:219], a[204:207], a[88:91], v[204:219]
  ds_read_b64_tr_b16 a[184:185], v97 offset:49152
  ds_read_b64_tr_b16 a[186:187], v97 offset:50176
  v_fmac_f32 v164, v121, v148
  v_fma_f32 v148, v120, v148, -v248
  v_mul_f32 v249, v121, v165
  v_mfma_f32_32x32x16_bf16 v[220:235], a[208:211], a[88:91], v[220:235]
  ds_read_b64_tr_b16 a[188:189], v98 offset:49152
  ds_read_b64_tr_b16 a[190:191], v98 offset:50176
  s_waitcnt lgkmcnt(6)
  v_mul_f32 v165, v120, v165
  v_fmac_f32 v165, v121, v149
  v_mfma_f32_32x32x16_bf16 v[172:187], a[164:167], a[92:95], v[172:187]
  ds_read_b64_tr_b16 a[192:193], v99 offset:49152
  s_add_u32 m0, s66, 102400
  ds_read_b64_tr_b16 a[194:195], v99 offset:50176
  buffer_load_dwordx4 v136, s[28:31], s88 offen lds
  v_fma_f32 v149, v120, v149, -v249
  s_waitcnt vmcnt(11)
  s_barrier
  v_mfma_f32_32x32x16_bf16 v[188:203], a[168:171], a[92:95], v[188:203]
  ds_read_b64_tr_b16 a[196:197], v84 offset:0
  ds_read_b64_tr_b16 a[198:199], v84 offset:1024
  v_mul_f32 v248, v121, v166
  v_mul_f32 v166, v120, v166
  v_fmac_f32 v166, v121, v150
  v_mfma_f32_32x32x16_bf16 v[204:219], a[172:175], a[92:95], v[204:219]
  ds_read_b64_tr_b16 a[200:201], v85 offset:0
  ds_read_b64_tr_b16 a[202:203], v85 offset:1024
  buffer_load_dwordx2 v[28:29], v125, s[40:43], 0 offen offset:256 sc0 sc1
  buffer_load_dwordx2 v[30:31], v125, s[40:43], 0 offen offset:512 sc0 sc1
  v_fma_f32 v150, v120, v150, -v248
  v_mfma_f32_32x32x16_bf16 v[220:235], a[176:179], a[92:95], v[220:235]
  ds_read_b64_tr_b16 a[204:205], v86 offset:0
  ds_read_b64_tr_b16 a[206:207], v86 offset:1024
  s_add_u32 m0, s67, 32768
  s_mov_b32 s70, 1376256
  buffer_load_dwordx4 v22, s[16:19], s70 offen offset:0 lds
  s_waitcnt lgkmcnt(6)
  v_mfma_f32_32x32x16_bf16 v[172:187], a[180:183], a[96:99], v[172:187]
  ds_read_b64_tr_b16 a[208:209], v87 offset:0
  ds_read_b64_tr_b16 a[210:211], v87 offset:1024
  v_mul_f32 v249, v121, v167
  v_mul_f32 v167, v120, v167
  v_mfma_f32_32x32x16_bf16 v[188:203], a[184:187], a[96:99], v[188:203]
  ds_read_b64_tr_b16 a[164:165], v88 offset:0
  ds_read_b64_tr_b16 a[166:167], v88 offset:1024
  v_fmac_f32 v167, v121, v151
  v_fma_f32 v151, v120, v151, -v249
  v_mul_f32 v248, v121, v168
  v_mfma_f32_32x32x16_bf16 v[204:219], a[188:191], a[96:99], v[204:219]
  ds_read_b64_tr_b16 a[168:169], v89 offset:0
  ds_read_b64_tr_b16 a[170:171], v89 offset:1024
  buffer_load_dwordx4 v23, s[16:19], s70 offen offset:1024 lds
  v_mul_f32 v168, v120, v168
  v_fmac_f32 v168, v121, v152
  v_mfma_f32_32x32x16_bf16 v[220:235], a[192:195], a[96:99], v[220:235]
  ds_read_b64_tr_b16 a[172:173], v90 offset:0
  ds_read_b64_tr_b16 a[174:175], v90 offset:1024
  s_waitcnt lgkmcnt(6)
  v_fma_f32 v152, v120, v152, -v248
  v_mul_f32 v249, v121, v169
  v_mfma_f32_32x32x16_bf16 v[172:187], a[196:199], a[100:103], v[172:187]
  ds_read_b64_tr_b16 a[176:177], v91 offset:0
  ds_read_b64_tr_b16 a[178:179], v91 offset:1024
  v_mul_f32 v169, v120, v169
  v_fmac_f32 v169, v121, v153
  v_fma_f32 v153, v120, v153, -v249
  v_mfma_f32_16x16x32_bf16 a[20:23], a[0:3], a[196:199], a[20:23]
  buffer_load_dwordx4 v24, s[16:19], s70 offen offset:2048 lds
  v_mul_f32 v248, v121, v170
  v_mfma_f32_32x32x16_bf16 v[188:203], a[200:203], a[100:103], v[188:203]
  ds_read_b64_tr_b16 a[180:181], v92 offset:0
  ds_read_b64_tr_b16 a[182:183], v92 offset:1024
  v_mul_f32 v170, v120, v170
  v_fmac_f32 v170, v121, v154
  v_fma_f32 v154, v120, v154, -v248
  v_mfma_f32_16x16x32_bf16 a[24:27], a[0:3], a[200:203], a[24:27]
  v_mul_f32 v249, v121, v171
  v_mul_f32 v171, v120, v171
  v_mfma_f32_32x32x16_bf16 v[204:219], a[204:207], a[100:103], v[204:219]
  ds_read_b64_tr_b16 a[184:185], v93 offset:0
  ds_read_b64_tr_b16 a[186:187], v93 offset:1024
  v_fmac_f32 v171, v121, v155
  v_fma_f32 v155, v120, v155, -v249
  s_xor_b32 s45, s61, 2
  v_mfma_f32_16x16x32_bf16 a[28:31], a[0:3], a[204:207], a[28:31]
  buffer_load_dwordx4 v25, s[16:19], s70 offen offset:3072 lds
  s_mulk_i32 s45, 11264
  v_mfma_f32_32x32x16_bf16 v[220:235], a[208:211], a[100:103], v[220:235]
  ds_read_b64_tr_b16 a[188:189], v94 offset:0
  ds_read_b64_tr_b16 a[190:191], v94 offset:1024
  s_xor_b32 s46, s61, 3
  s_mulk_i32 s46, 11264
  v_xor_b32 v11, 0, v55
  v_mfma_f32_16x16x32_bf16 a[32:35], a[0:3], a[208:211], a[32:35]
  s_waitcnt lgkmcnt(6)
  v_add_u32 v254, 77824, v11
  v_mfma_f32_32x32x16_bf16 v[172:187], a[164:167], a[104:107], v[172:187]
  ds_read_b64_tr_b16 a[192:193], v95 offset:0
  ds_read_b64_tr_b16 a[194:195], v95 offset:1024
  v_add_u32 v255, 143360, v11
  v_xor_b32 v11, 32, v55
  v_add_u32 v17, 77824, v11
  v_mfma_f32_32x32x16_bf16 v[188:203], a[168:171], a[104:107], v[188:203]
  ds_read_b64_tr_b16 a[196:197], v96 offset:0
  s_add_u32 m0, s66, 106496
  ds_read_b64_tr_b16 a[198:199], v96 offset:1024
  buffer_load_dwordx4 v135, s[20:23], s78 offen lds
  v_add_u32 v18, 143360, v11
  v_mfma_f32_32x32x16_bf16 v[204:219], a[172:175], a[104:107], v[204:219]
  ds_read_b64_tr_b16 a[200:201], v97 offset:0
  ds_read_b64_tr_b16 a[202:203], v97 offset:1024
  v_xor_b32 v11, 64, v55
  v_add_u32 v19, 77824, v11
  v_add_u32 v20, 143360, v11
  v_mfma_f32_32x32x16_bf16 v[220:235], a[176:179], a[104:107], v[220:235]
  ds_read_b64_tr_b16 a[204:205], v98 offset:0
  ds_read_b64_tr_b16 a[206:207], v98 offset:1024
  s_waitcnt lgkmcnt(6)
  v_xor_b32 v11, 96, v55
  v_add_u32 v21, 77824, v11
  v_mfma_f32_32x32x16_bf16 v[172:187], a[180:183], a[108:111], v[172:187]
  ds_read_b64_tr_b16 a[208:209], v99 offset:0
  ds_read_b64_tr_b16 a[210:211], v99 offset:1024
  s_add_u32 m0, s66, 110592
  s_add_u32 s70, s78, 16384
  buffer_load_dwordx4 v135, s[20:23], s70 offen lds
  s_waitcnt vmcnt(14)
  s_barrier
  v_mfma_f32_32x32x16_bf16 v[188:203], a[184:187], a[108:111], v[188:203]
  ds_read_b64_tr_b16 a[164:165], v84 offset:16384
  ds_read_b64_tr_b16 a[166:167], v84 offset:17408
  v_add_u32 v57, 143360, v11
  v_lshl_add_u32 v12, v3, 10, v56
  v_xor_b32 v11, 0, v12
  v_mfma_f32_32x32x16_bf16 v[204:219], a[188:191], a[108:111], v[204:219]
  ds_read_b64_tr_b16 a[168:169], v85 offset:16384
  ds_read_b64_tr_b16 a[170:171], v85 offset:17408
  v_add_u32 v27, 0, v11
  v_add_u32 v50, 65536, v11
  v_add_u32 v52, 131072, v11
  v_mfma_f32_32x32x16_bf16 v[220:235], a[192:195], a[108:111], v[220:235]
  ds_read_b64_tr_b16 a[172:173], v86 offset:16384
  ds_read_b64_tr_b16 a[174:175], v86 offset:17408
  s_waitcnt lgkmcnt(6)
  s_add_u32 m0, s67, 49152
  s_mov_b32 s70, 1605632
  buffer_load_dwordx4 v22, s[16:19], s70 offen offset:0 lds
  s_waitcnt vmcnt(7)
  v_xor_b32 v4, v28, v137
  v_bitop3_b32 v4, v4, v29, v137 bitop3:0xf6
  v_bitop3_b32 v4, v4, v30, v137 bitop3:0xf6
  v_bitop3_b32 v4, v4, v31, v137 bitop3:0xf6
  v_and_b32 v4, 0x3ff, v4
  v_cmp_ne_u32 vcc, 0, v4
  s_cbranch_vccnz L_sp3
L_ok3:
  v_mfma_f32_32x32x16_bf16 v[172:187], a[196:199], a[112:115], v[172:187]
  ds_read_b64_tr_b16 a[176:177], v87 offset:16384
  ds_read_b64_tr_b16 a[178:179], v87 offset:17408
  v_xor_b32 v28, v28, v137
  v_xor_b32 v29, v29, v137
  v_xor_b32 v30, v30, v137
  v_xor_b32 v31, v31, v137
  v_fma_f32 v28, v30, v114, v28
  v_mfma_f32_32x32x16_bf16 v[188:203], a[200:203], a[112:115], v[188:203]
  ds_read_b64_tr_b16 a[180:181], v88 offset:16384
  ds_read_b64_tr_b16 a[182:183], v88 offset:17408
  buffer_load_dwordx4 v23, s[16:19], s70 offen offset:1024 lds
  v_fma_f32 v29, v30, v115, v29
  v_fma_f32 v28, -v31, v115, v28
  v_fma_f32 v29, v31, v114, v29
  v_mul_f32 v122, v29, v117
  v_mfma_f32_32x32x16_bf16 v[204:219], a[204:207], a[112:115], v[204:219]
  ds_read_b64_tr_b16 a[184:185], v89 offset:16384
  ds_read_b64_tr_b16 a[186:187], v89 offset:17408
  v_mul_f32 v123, v28, v117
  v_fma_f32 v122, v28, v116, -v122
  v_fma_f32 v123, v29, v116, v123
  v_lshlrev_b32 v4, 3, v2
  v_add_u32 v4, 161536, v4
  v_mfma_f32_32x32x16_bf16 v[220:235], a[208:211], a[112:115], v[220:235]
  ds_read_b64_tr_b16 a[188:189], v90 offset:16384
  ds_read_b64_tr_b16 a[190:191], v90 offset:17408
  s_waitcnt lgkmcnt(6)
  ds_write_b64 v132, v[122:123] offset:1792
  v_xor_b32 v11, 64, v12
  v_mfma_f32_32x32x16_bf16 v[172:187], a[164:167], a[116:119], v[172:187]
  ds_read_b64_tr_b16 a[192:193], v91 offset:16384
  ds_read_b64_tr_b16 a[194:195], v91 offset:17408
  buffer_load_dwordx4 v24, s[16:19], s70 offen offset:2048 lds
  v_add_u32 v53, 0, v11
  v_add_u32 v242, 65536, v11
  v_mfma_f32_16x16x32_bf16 a[20:23], a[0:3], a[164:167], a[20:23]
  s_waitcnt lgkmcnt(2)
  s_barrier
  ds_read2_b64 v[28:31], v4 offset0:0 offset1:32
  ds_read2_b64 v[32:35], v4 offset0:64 offset1:96
  v_mfma_f32_32x32x16_bf16 v[188:203], a[168:171], a[116:119], v[188:203]
  ds_read_b64_tr_b16 a[196:197], v92 offset:16384
  ds_read_b64_tr_b16 a[198:199], v92 offset:17408
  ds_read2_b64 v[36:39], v4 offset0:128 offset1:160
  ds_read2_b64 v[40:43], v4 offset0:192 offset1:224
  v_add_u32 v243, 131072, v11
  v_mfma_f32_16x16x32_bf16 a[24:27], a[0:3], a[168:171], a[24:27]
  buffer_load_dwordx4 v25, s[16:19], s70 offen offset:3072 lds
  v_xor_b32 v11, 128, v12
  v_mfma_f32_32x32x16_bf16 v[204:219], a[172:175], a[116:119], v[204:219]
  ds_read_b64_tr_b16 a[200:201], v93 offset:16384
  ds_read_b64_tr_b16 a[202:203], v93 offset:17408
  v_add_u32 v45, 0, v11
  v_add_u32 v46, 65536, v11
  v_add_u32 v47, 131072, v11
  v_mfma_f32_16x16x32_bf16 a[28:31], a[0:3], a[172:175], a[28:31]
  v_xor_b32 v11, 192, v12
  v_add_u32_e64 v48, 0, v11
  v_mfma_f32_32x32x16_bf16 v[220:235], a[176:179], a[116:119], v[220:235]
  ds_read_b64_tr_b16 a[204:205], v94 offset:16384
  ds_read_b64_tr_b16 a[206:207], v94 offset:17408
  v_add_u32 v252, 65536, v11
  v_add_u32 v253, 131072, v11
  s_waitcnt lgkmcnt(4)
  v_pk_add_f32 v[28:29], v[28:29], v[30:31]
  v_pk_add_f32 v[32:33], v[32:33], v[34:35]
  v_pk_add_f32 v[36:37], v[36:37], v[38:39]
  v_pk_add_f32 v[40:41], v[40:41], v[42:43]
  v_pk_add_f32 v[28:29], v[28:29], v[32:33]
  v_pk_add_f32 v[36:37], v[36:37], v[40:41]
  v_pk_add_f32 v[28:29], v[28:29], v[36:37]
  v_fma_f32 v32, v28, v118, v128
  v_fma_f32 v34, v28, v119, v129
  v_fma_f32 v32, -v29, v119, v32
  v_fma_f32 v34, v29, v118, v34
  v_fma_f32 v33, v32, v110, v244
  v_fma_f32 v35, v32, v111, v246
  v_fma_f32 v33, -v34, v111, v33
  v_fma_f32 v35, v34, v110, v35
  v_pk_mul_f32 v[36:37], v[32:33], v[120:121] op_sel_hi:[1,0]
  v_pk_mul_f32 v[38:39], v[34:35], v[120:121] op_sel_hi:[1,0]
  v_pk_fma_f32 v[36:37], v[34:35], v[120:121], v[36:37] op_sel:[0,1,0] op_sel_hi:[1,1,1] neg_lo:[0,1,0] neg_hi:[0,1,0]
  v_pk_fma_f32 v[38:39], v[32:33], v[120:121], v[38:39] op_sel:[0,1,0] op_sel_hi:[1,1,1]
  v_pk_fma_f32 v[140:141], v[36:37], v[108:109], v[140:141] op_sel:[0,0,0] op_sel_hi:[1,0,1]
  v_pk_fma_f32 v[156:157], v[38:39], v[108:109], v[156:157] op_sel:[0,0,0] op_sel_hi:[1,0,1]
  v_pk_fma_f32 v[140:141], v[38:39], v[108:109], v[140:141] op_sel:[0,1,0] op_sel_hi:[1,1,1] neg_lo:[0,1,0] neg_hi:[0,1,0]
  v_pk_fma_f32 v[156:157], v[36:37], v[108:109], v[156:157] op_sel:[0,1,0] op_sel_hi:[1,1,1]
  v_pk_fma_f32 v[142:143], v[140:141], v[108:109], v[142:143] op_sel:[0,0,0] op_sel_hi:[1,0,1]
  v_pk_fma_f32 v[158:159], v[156:157], v[108:109], v[158:159] op_sel:[0,0,0] op_sel_hi:[1,0,1]
  v_pk_fma_f32 v[142:143], v[156:157], v[108:109], v[142:143] op_sel:[0,1,0] op_sel_hi:[1,1,1] neg_lo:[0,1,0] neg_hi:[0,1,0]
  v_pk_fma_f32 v[158:159], v[140:141], v[108:109], v[158:159] op_sel:[0,1,0] op_sel_hi:[1,1,1]
  v_pk_fma_f32 v[144:145], v[142:143], v[108:109], v[144:145] op_sel:[0,0,0] op_sel_hi:[1,0,1]
  v_pk_fma_f32 v[160:161], v[158:159], v[108:109], v[160:161] op_sel:[0,0,0] op_sel_hi:[1,0,1]
  v_pk_fma_f32 v[144:145], v[158:159], v[108:109], v[144:145] op_sel:[0,1,0] op_sel_hi:[1,1,1] neg_lo:[0,1,0] neg_hi:[0,1,0]
  v_pk_fma_f32 v[160:161], v[142:143], v[108:109], v[160:161] op_sel:[0,1,0] op_sel_hi:[1,1,1]
  v_pk_fma_f32 v[146:147], v[144:145], v[108:109], v[146:147] op_sel:[0,0,0] op_sel_hi:[1,0,1]
  v_pk_fma_f32 v[162:163], v[160:161], v[108:109], v[162:163] op_sel:[0,0,0] op_sel_hi:[1,0,1]
  v_pk_fma_f32 v[146:147], v[160:161], v[108:109], v[146:147] op_sel:[0,1,0] op_sel_hi:[1,1,1] neg_lo:[0,1,0] neg_hi:[0,1,0]
  v_pk_fma_f32 v[162:163], v[144:145], v[108:109], v[162:163] op_sel:[0,1,0] op_sel_hi:[1,1,1]
  v_pk_fma_f32 v[148:149], v[146:147], v[108:109], v[148:149] op_sel:[0,0,0] op_sel_hi:[1,0,1]
  v_pk_fma_f32 v[164:165], v[162:163], v[108:109], v[164:165] op_sel:[0,0,0] op_sel_hi:[1,0,1]
  v_pk_fma_f32 v[148:149], v[162:163], v[108:109], v[148:149] op_sel:[0,1,0] op_sel_hi:[1,1,1] neg_lo:[0,1,0] neg_hi:[0,1,0]
  v_pk_fma_f32 v[164:165], v[146:147], v[108:109], v[164:165] op_sel:[0,1,0] op_sel_hi:[1,1,1]
  v_pk_fma_f32 v[150:151], v[148:149], v[108:109], v[150:151] op_sel:[0,0,0] op_sel_hi:[1,0,1]
  v_pk_fma_f32 v[166:167], v[164:165], v[108:109], v[166:167] op_sel:[0,0,0] op_sel_hi:[1,0,1]
  v_pk_fma_f32 v[150:151], v[164:165], v[108:109], v[150:151] op_sel:[0,1,0] op_sel_hi:[1,1,1] neg_lo:[0,1,0] neg_hi:[0,1,0]
  v_pk_fma_f32 v[166:167], v[148:149], v[108:109], v[166:167] op_sel:[0,1,0] op_sel_hi:[1,1,1]
  v_pk_fma_f32 v[152:153], v[150:151], v[108:109], v[152:153] op_sel:[0,0,0] op_sel_hi:[1,0,1]
  v_pk_fma_f32 v[168:169], v[166:167], v[108:109], v[168:169] op_sel:[0,0,0] op_sel_hi:[1,0,1]
  v_pk_fma_f32 v[152:153], v[166:167], v[108:109], v[152:153] op_sel:[0,1,0] op_sel_hi:[1,1,1] neg_lo:[0,1,0] neg_hi:[0,1,0]
  v_pk_fma_f32 v[168:169], v[150:151], v[108:109], v[168:169] op_sel:[0,1,0] op_sel_hi:[1,1,1]
  v_pk_fma_f32 v[154:155], v[152:153], v[108:109], v[154:155] op_sel:[0,0,0] op_sel_hi:[1,0,1]
  v_pk_fma_f32 v[170:171], v[168:169], v[108:109], v[170:171] op_sel:[0,0,0] op_sel_hi:[1,0,1]
  v_pk_fma_f32 v[154:155], v[168:169], v[108:109], v[154:155] op_sel:[0,1,0] op_sel_hi:[1,1,1] neg_lo:[0,1,0] neg_hi:[0,1,0]
  v_pk_fma_f32 v[170:171], v[152:153], v[108:109], v[170:171] op_sel:[0,1,0] op_sel_hi:[1,1,1]
  s_nop 1
  v_mfma_f32_16x16x32_bf16 a[32:35], a[0:3], a[176:179], a[32:35]
  s_add_u32 m0, s66, 114688
  s_add_u32 s70, s78, 32768
  buffer_load_dwordx4 v135, s[20:23], s70 offen lds
  v_mfma_f32_32x32x16_bf16 v[172:187], a[180:183], a[120:123], v[172:187]
  ds_read_b64_tr_b16 a[208:209], v95 offset:16384
  ds_read_b64_tr_b16 a[210:211], v95 offset:17408
  v_cvt_pk_bf16_f32 v28, v140, v141
  v_cvt_pk_bf16_f32 v29, v142, v143
  v_cvt_pk_bf16_f32 v30, v144, v145
  v_cvt_pk_bf16_f32 v31, v146, v147
  v_cvt_pk_bf16_f32 v32, v148, v149
  v_mfma_f32_32x32x16_bf16 v[188:203], a[184:187], a[120:123], v[188:203]
  ds_read_b64_tr_b16 a[164:165], v96 offset:16384
  ds_read_b64_tr_b16 a[166:167], v96 offset:17408
  v_cvt_pk_bf16_f32 v33, v150, v151
  v_cvt_pk_bf16_f32 v34, v152, v153
  v_cvt_pk_bf16_f32 v35, v154, v155
  v_cvt_pk_bf16_f32 v36, v156, v157
  v_cvt_pk_bf16_f32 v37, v158, v159
  v_mfma_f32_32x32x16_bf16 v[204:219], a[188:191], a[120:123], v[204:219]
  ds_read_b64_tr_b16 a[168:169], v97 offset:16384
  ds_read_b64_tr_b16 a[170:171], v97 offset:17408
  s_add_u32 m0, s66, 118784
  s_add_u32 s70, s78, 49152
  buffer_load_dwordx4 v135, s[20:23], s70 offen lds
  v_cvt_pk_bf16_f32 v38, v160, v161
  v_cvt_pk_bf16_f32 v39, v162, v163
  v_mfma_f32_32x32x16_bf16 v[220:235], a[192:195], a[120:123], v[220:235]
  ds_read_b64_tr_b16 a[172:173], v98 offset:16384
  ds_read_b64_tr_b16 a[174:175], v98 offset:17408
  s_waitcnt lgkmcnt(6)
  v_cvt_pk_bf16_f32 v40, v164, v165
  v_cvt_pk_bf16_f32 v41, v166, v167
  v_cvt_pk_bf16_f32 v42, v168, v169
  v_cvt_pk_bf16_f32 v43, v170, v171
  v_mfma_f32_32x32x16_bf16 v[172:187], a[196:199], a[124:127], v[172:187]
  ds_read_b64_tr_b16 a[176:177], v99 offset:16384
  ds_read_b64_tr_b16 a[178:179], v99 offset:17408
  s_mul_i32 s69, s61, 11264
  s_add_u32 s69, s69, 7168
  v_mfma_f32_32x32x16_bf16 v[140:155], v[28:31], a[12:15], 0
  v_mfma_f32_32x32x16_bf16 v[140:155], v[32:35], a[16:19], v[140:155]
  v_mfma_f32_32x32x16_bf16 v[156:171], v[36:39], a[12:15], 0
  v_mfma_f32_32x32x16_bf16 v[156:171], v[40:43], a[16:19], v[156:171]
  s_waitcnt vmcnt(8)
  s_barrier
  v_mfma_f32_32x32x16_bf16 v[188:203], a[200:203], a[124:127], v[188:203]
  ds_read_b64_tr_b16 a[180:181], v84 offset:32768
  ds_read_b64_tr_b16 a[182:183], v84 offset:33792
  s_add_u32 m0, s66, 65536
  s_add_u32 s70, s78, 65536
  buffer_load_dwordx4 v135, s[20:23], s70 offen lds
  s_nop 1
  v_cvt_pk_bf16_f32 v244, v140, v141
  v_cvt_pk_bf16_f32 v245, v142, v143
  v_mfma_f32_32x32x16_bf16 v[204:219], a[204:207], a[124:127], v[204:219]
  ds_read_b64_tr_b16 a[184:185], v85 offset:32768
  ds_read_b64_tr_b16 a[186:187], v85 offset:33792
  v_cvt_pk_bf16_f32 v246, v144, v145
  v_cvt_pk_bf16_f32 v247, v146, v147
  buffer_store_dwordx4 v[244:247], v51, s[32:35], s69 offen offset:0 sc1
  v_cvt_pk_bf16_f32 v248, v148, v149
  v_cvt_pk_bf16_f32 v249, v150, v151
  v_mfma_f32_32x32x16_bf16 v[220:235], a[208:211], a[124:127], v[220:235]
  ds_read_b64_tr_b16 a[188:189], v86 offset:32768
  ds_read_b64_tr_b16 a[190:191], v86 offset:33792
  s_waitcnt lgkmcnt(6)
  v_cvt_pk_bf16_f32 v250, v152, v153
  v_cvt_pk_bf16_f32 v251, v154, v155
  buffer_store_dwordx4 v[248:251], v51, s[32:35], s69 offen offset:1024 sc1
  v_cvt_pk_bf16_f32 v124, v156, v157
  v_mfma_f32_32x32x16_bf16 v[172:187], a[164:167], a[128:131], v[172:187]
  ds_read_b64_tr_b16 a[192:193], v87 offset:32768
  ds_read_b64_tr_b16 a[194:195], v87 offset:33792
  s_add_u32 m0, s66, 69632
  s_add_u32 s70, s78, 81920
  buffer_load_dwordx4 v135, s[20:23], s70 offen lds
  v_cvt_pk_bf16_f32 v125, v158, v159
  v_cvt_pk_bf16_f32 v126, v160, v161
  v_mfma_f32_32x32x16_bf16 v[188:203], a[168:171], a[128:131], v[188:203]
  ds_read_b64_tr_b16 a[196:197], v88 offset:32768
  ds_read_b64_tr_b16 a[198:199], v88 offset:33792
  v_cvt_pk_bf16_f32 v127, v162, v163
  buffer_store_dwordx4 v[124:127], v51, s[32:35], s69 offen offset:2048 sc1
  v_cvt_pk_bf16_f32 v128, v164, v165
  v_cvt_pk_bf16_f32 v129, v166, v167
  v_cvt_pk_bf16_f32 v130, v168, v169
  v_mfma_f32_32x32x16_bf16 v[204:219], a[172:175], a[128:131], v[204:219]
  ds_read_b64_tr_b16 a[200:201], v89 offset:32768
  ds_read_b64_tr_b16 a[202:203], v89 offset:33792
  v_cvt_pk_bf16_f32 v131, v170, v171
  buffer_store_dwordx4 v[128:131], v51, s[32:35], s69 offen offset:3072 sc1
  v_mfma_f32_32x32x16_bf16 v[220:235], a[176:179], a[128:131], v[220:235]
  ds_read_b64_tr_b16 a[204:205], v92 offset:32768
  ds_read_b64_tr_b16 a[206:207], v92 offset:33792
  s_add_u32 m0, s66, 73728
  s_waitcnt lgkmcnt(6)
  buffer_load_dwordx4 v135, s[20:23], s82 offen lds
  v_mfma_f32_32x32x16_bf16 v[172:187], a[180:183], a[132:135], v[172:187]
  ds_read_b64_tr_b16 a[208:209], v93 offset:32768
  ds_read_b64_tr_b16 a[210:211], v93 offset:33792
  v_mfma_f32_16x16x32_bf16 a[20:23], a[0:3], a[180:183], a[20:23]
  v_mfma_f32_32x32x16_bf16 v[188:203], a[184:187], a[132:135], v[188:203]
  ds_read_b64_tr_b16 a[164:165], v96 offset:32768
  s_add_u32 m0, s66, 77824
  ds_read_b64_tr_b16 a[166:167], v96 offset:33792
  buffer_load_dwordx4 v26, s[24:27], s86 offen lds
  v_mfma_f32_16x16x32_bf16 a[24:27], a[0:3], a[184:187], a[24:27]
  v_mfma_f32_16x16x32_bf16 a[28:31], a[0:3], a[188:191], a[28:31]
  ds_read_b64_tr_b16 a[168:169], v97 offset:32768
  ds_read_b64_tr_b16 a[170:171], v97 offset:33792
  s_waitcnt vmcnt(10)
  s_barrier
  v_mfma_f32_16x16x32_bf16 a[32:35], a[0:3], a[192:195], a[32:35]
  ds_read_b64_tr_b16 a[172:173], v84 offset:49152
  ds_read_b64_tr_b16 a[174:175], v84 offset:50176
  s_waitcnt lgkmcnt(6)
  v_mfma_f32_32x32x16_bf16 v[172:187], a[196:199], a[136:139], v[172:187]
  ds_read_b64_tr_b16 a[176:177], v85 offset:49152
  s_add_u32 m0, s66, 122880
  ds_read_b64_tr_b16 a[178:179], v85 offset:50176
  buffer_load_dwordx4 v26, s[28:31], s86 offen lds
  v_mfma_f32_32x32x16_bf16 v[188:203], a[200:203], a[136:139], v[188:203]
  ds_read_b64_tr_b16 a[180:181], v86 offset:49152
  ds_read_b64_tr_b16 a[182:183], v86 offset:50176
  v_mfma_f32_32x32x16_bf16 v[172:187], a[204:207], a[140:143], v[172:187]
  ds_read_b64_tr_b16 a[184:185], v87 offset:49152
  ds_read_b64_tr_b16 a[186:187], v87 offset:50176
  v_mfma_f32_32x32x16_bf16 v[188:203], a[208:211], a[140:143], v[188:203]
  ds_read_b64_tr_b16 a[188:189], v88 offset:49152
  ds_read_b64_tr_b16 a[190:191], v88 offset:50176
  s_add_u32 m0, s66, 126976
  s_waitcnt lgkmcnt(6)
  buffer_load_dwordx4 v26, s[24:27], s87 offen lds
  v_mfma_f32_32x32x16_bf16 v[172:187], a[164:167], a[144:147], v[172:187]
  ds_read_b64_tr_b16 a[192:193], v89 offset:49152
  ds_read_b64_tr_b16 a[194:195], v89 offset:50176
  v_mfma_f32_32x32x16_bf16 v[188:203], a[168:171], a[144:147], v[188:203]
  ds_read_b64_tr_b16 a[196:197], v92 offset:49152
  ds_read_b64_tr_b16 a[198:199], v92 offset:50176
  v_mfma_f32_32x32x16_bf16 v[172:187], a[172:175], a[148:151], v[172:187]
  ds_read_b64_tr_b16 a[200:201], v93 offset:49152
  s_add_u32 m0, s66, 81920
  ds_read_b64_tr_b16 a[202:203], v93 offset:50176
  buffer_load_dwordx4 v26, s[24:27], s88 offen lds
  v_mfma_f32_16x16x32_bf16 a[20:23], a[0:3], a[172:175], a[20:23]
  v_mfma_f32_32x32x16_bf16 v[188:203], a[176:179], a[148:151], v[188:203]
  ds_read_b64_tr_b16 a[204:205], v96 offset:49152
  ds_read_b64_tr_b16 a[206:207], v96 offset:50176
  v_mfma_f32_16x16x32_bf16 a[24:27], a[0:3], a[176:179], a[24:27]
  s_add_u32 m0, s66, 86016
  s_waitcnt lgkmcnt(6)
  buffer_load_dwordx4 v135, s[20:23], s79 offen lds
  v_mfma_f32_16x16x32_bf16 a[28:31], a[0:3], a[180:183], a[28:31]
  ds_read_b64_tr_b16 a[208:209], v97 offset:49152
  ds_read_b64_tr_b16 a[210:211], v97 offset:50176
  v_mfma_f32_16x16x32_bf16 a[32:35], a[0:3], a[184:187], a[32:35]
  ds_read_b64_tr_b16 a[164:165], v86 offset:32768
  ds_read_b64_tr_b16 a[166:167], v86 offset:33792
  v_mfma_f32_32x32x16_bf16 v[172:187], a[188:191], a[152:155], v[172:187]
  ds_read_b64_tr_b16 a[168:169], v87 offset:32768
  ds_read_b64_tr_b16 a[170:171], v87 offset:33792
  v_mfma_f32_32x32x16_bf16 v[188:203], a[192:195], a[152:155], v[188:203]
  ds_read_b64_tr_b16 a[172:173], v90 offset:32768
  ds_read_b64_tr_b16 a[174:175], v90 offset:33792
  s_waitcnt lgkmcnt(6)
  s_add_u32 m0, s66, 90112
  s_add_u32 s70, s79, 16384
  buffer_load_dwordx4 v135, s[20:23], s70 offen lds
  ds_write_b32 v83, a20 offset:0
  v_mfma_f32_32x32x16_bf16 v[172:187], a[196:199], a[156:159], v[172:187]
  ds_read_b64_tr_b16 a[176:177], v91 offset:32768
  ds_read_b64_tr_b16 a[178:179], v91 offset:33792
  ds_write_b32 v83, a24 offset:512
  ds_write_b32 v83, a28 offset:1024
  ds_write_b32 v83, a32 offset:1536
  v_mfma_f32_32x32x16_bf16 v[188:203], a[200:203], a[156:159], v[188:203]
  ds_read_b64_tr_b16 a[180:181], v94 offset:32768
  ds_read_b64_tr_b16 a[182:183], v94 offset:33792
  v_mfma_f32_32x32x16_bf16 v[172:187], a[204:207], a[160:163], v[172:187]
  ds_read_b64_tr_b16 a[184:185], v95 offset:32768
  ds_read_b64_tr_b16 a[186:187], v95 offset:33792
  s_add_u32 m0, s66, 94208
  s_add_u32 s70, s79, 32768
  buffer_load_dwordx4 v135, s[20:23], s70 offen lds
  s_waitcnt lgkmcnt(4)
  s_barrier
  v_mfma_f32_32x32x16_bf16 v[188:203], a[208:211], a[160:163], v[188:203]
  ds_read_b64_tr_b16 a[188:189], v98 offset:32768
  ds_read_b64_tr_b16 a[190:191], v98 offset:33792
  ds_read2_b64 v[100:103], v82 offset0:0 offset1:32
  ds_read2_b64 v[104:107], v82 offset0:64 offset1:96
  v_mfma_f32_32x32x16_bf16 v[204:219], a[164:167], a[132:135], v[204:219]
  ds_read_b64_tr_b16 a[192:193], v99 offset:32768
  ds_read_b64_tr_b16 a[194:195], v99 offset:33792
  v_mfma_f32_32x32x16_bf16 v[220:235], a[168:171], a[132:135], v[220:235]
  ds_read_b64_tr_b16 a[196:197], v86 offset:49152
  ds_read_b64_tr_b16 a[198:199], v86 offset:50176
  s_add_u32 m0, s66, 131072
  s_add_u32 s70, s79, 49152
  buffer_load_dwordx4 v135, s[20:23], s70 offen lds
  v_mfma_f32_32x32x16_bf16 v[204:219], a[172:175], a[136:139], v[204:219]
  ds_read_b64_tr_b16 a[200:201], v87 offset:49152
  ds_read_b64_tr_b16 a[202:203], v87 offset:50176
  s_waitcnt lgkmcnt(7)
  v_add_f32 v100, v100, v101
  v_add_f32 v102, v102, v103
  v_add_f32 v100, v100, v102
  v_and_b32 v101, 0xffff0000, v100
  v_sub_f32 v102, v100, v101
  v_mfma_f32_32x32x16_bf16 v[220:235], a[176:179], a[136:139], v[220:235]
  ds_read_b64_tr_b16 a[204:205], v90 offset:49152
  ds_read_b64_tr_b16 a[206:207], v90 offset:50176
  s_waitcnt lgkmcnt(6)
  v_cvt_pk_bf16_f32 v72, v101, v102
  v_add_f32 v104, v104, v105
  v_add_f32 v106, v106, v107
  v_add_f32 v104, v104, v106
  v_mfma_f32_32x32x16_bf16 v[204:219], a[180:183], a[140:143], v[204:219]
  ds_read_b64_tr_b16 a[208:209], v91 offset:49152
  s_add_u32 m0, s66, 135168
  ds_read_b64_tr_b16 a[210:211], v91 offset:50176
  buffer_load_dwordx4 v135, s[20:23], s80 offen lds
  v_and_b32 v105, 0xffff0000, v104
  v_sub_f32 v106, v104, v105
  v_cvt_pk_bf16_f32 v74, v105, v106
  v_mfma_f32_32x32x16_bf16 v[220:235], a[184:187], a[140:143], v[220:235]
  ds_read_b64_tr_b16 a[164:165], v94 offset:49152
  ds_read_b64_tr_b16 a[166:167], v94 offset:50176
  v_mfma_f32_32x32x8_bf16 v[172:187], v[72:73], v[240:241], v[172:187]
  v_mfma_f32_32x32x8_bf16 v[188:203], v[74:75], v[240:241], v[188:203]
  v_mfma_f32_32x32x16_bf16 v[204:219], a[188:191], a[144:147], v[204:219]
  ds_read_b64_tr_b16 a[168:169], v95 offset:49152
  ds_read_b64_tr_b16 a[170:171], v95 offset:50176
  s_mul_i32 s76, s61, 11264
  s_nop 6
  v_pk_mul_f32 v[100:101], v[172:173], v[172:173]
  v_pk_mul_f32 v[102:103], v[174:175], v[174:175]
  v_pk_mul_f32 v[104:105], v[176:177], v[176:177]
  v_pk_mul_f32 v[106:107], v[178:179], v[178:179]
  v_pk_fma_f32 v[100:101], v[100:101], v[238:239], v[238:239] op_sel:[0,1,0] op_sel_hi:[1,1,0]
  v_pk_fma_f32 v[102:103], v[102:103], v[238:239], v[238:239] op_sel:[0,1,0] op_sel_hi:[1,1,0]
  v_pk_fma_f32 v[104:105], v[104:105], v[238:239], v[238:239] op_sel:[0,1,0] op_sel_hi:[1,1,0]
  v_pk_fma_f32 v[106:107], v[106:107], v[238:239], v[238:239] op_sel:[0,1,0] op_sel_hi:[1,1,0]
  v_pk_mul_f32 v[100:101], v[100:101], v[172:173]
  v_pk_mul_f32 v[102:103], v[102:103], v[174:175]
  v_pk_mul_f32 v[104:105], v[104:105], v[176:177]
  v_pk_mul_f32 v[106:107], v[106:107], v[178:179]
  s_add_u32 m0, s66, 0
  s_add_u32 s70, s80, 16384
  buffer_load_dwordx4 v135, s[20:23], s70 offen lds
  v_exp_f32 v100, v100
  v_exp_f32 v101, v101
  v_exp_f32 v102, v102
  v_exp_f32 v103, v103
  v_exp_f32 v104, v104
  v_exp_f32 v105, v105
  v_exp_f32 v106, v106
  v_exp_f32 v107, v107
  v_pk_fma_f32 v[100:101], v[100:101], v[236:237], v[236:237] op_sel_hi:[1,0,0]
  v_pk_fma_f32 v[102:103], v[102:103], v[236:237], v[236:237] op_sel_hi:[1,0,0]
  v_pk_fma_f32 v[104:105], v[104:105], v[236:237], v[236:237] op_sel_hi:[1,0,0]
  v_pk_fma_f32 v[106:107], v[106:107], v[236:237], v[236:237] op_sel_hi:[1,0,0]
  v_rcp_f32 v100, v100
  v_rcp_f32 v101, v101
  v_rcp_f32 v102, v102
  v_rcp_f32 v103, v103
  v_rcp_f32 v104, v104
  v_rcp_f32 v105, v105
  v_rcp_f32 v106, v106
  v_rcp_f32_e64 v107, v107
  s_add_u32 m0, s66, 4096
  s_add_u32 s70, s80, 32768
  buffer_load_dwordx4 v135, s[20:23], s70 offen lds
  v_pk_mul_f32 v[100:101], v[100:101], v[172:173]
  v_pk_mul_f32 v[102:103], v[102:103], v[174:175]
  v_pk_mul_f32 v[104:105], v[104:105], v[176:177]
  v_pk_mul_f32 v[106:107], v[106:107], v[178:179]
  v_cvt_pk_bf16_f32 v172, v100, v101
  v_cvt_pk_bf16_f32 v173, v102, v103
  v_cvt_pk_bf16_f32 v174, v104, v105
  v_cvt_pk_bf16_f32 v175, v106, v107
  buffer_store_dwordx4 v[172:175], v51, s[32:35], s76 offen offset:0 sc1
  v_pk_mul_f32 v[100:101], v[180:181], v[180:181]
  v_pk_mul_f32 v[102:103], v[182:183], v[182:183]
  v_pk_mul_f32 v[104:105], v[184:185], v[184:185]
  v_pk_mul_f32 v[106:107], v[186:187], v[186:187]
  v_pk_fma_f32 v[100:101], v[100:101], v[238:239], v[238:239] op_sel:[0,1,0] op_sel_hi:[1,1,0]
  v_pk_fma_f32 v[102:103], v[102:103], v[238:239], v[238:239] op_sel:[0,1,0] op_sel_hi:[1,1,0]
  v_pk_fma_f32 v[104:105], v[104:105], v[238:239], v[238:239] op_sel:[0,1,0] op_sel_hi:[1,1,0]
  v_pk_fma_f32 v[106:107], v[106:107], v[238:239], v[238:239] op_sel:[0,1,0] op_sel_hi:[1,1,0]
  v_pk_mul_f32 v[100:101], v[100:101], v[180:181]
  v_pk_mul_f32 v[102:103], v[102:103], v[182:183]
  v_pk_mul_f32 v[104:105], v[104:105], v[184:185]
  v_pk_mul_f32 v[106:107], v[106:107], v[186:187]
  v_exp_f32 v100, v100
  v_exp_f32 v101, v101
  v_exp_f32 v102, v102
  v_exp_f32 v103, v103
  v_exp_f32 v104, v104
  v_exp_f32 v105, v105
  v_exp_f32 v106, v106
  v_exp_f32 v107, v107
  s_add_u32 m0, s66, 8192
  s_add_u32 s70, s80, 49152
  buffer_load_dwordx4 v135, s[20:23], s70 offen lds
  v_pk_fma_f32 v[100:101], v[100:101], v[236:237], v[236:237] op_sel_hi:[1,0,0]
  v_pk_fma_f32 v[102:103], v[102:103], v[236:237], v[236:237] op_sel_hi:[1,0,0]
  v_pk_fma_f32 v[104:105], v[104:105], v[236:237], v[236:237] op_sel_hi:[1,0,0]
  v_pk_fma_f32 v[106:107], v[106:107], v[236:237], v[236:237] op_sel_hi:[1,0,0]
  v_rcp_f32 v100, v100
  v_rcp_f32 v101, v101
  v_rcp_f32 v102, v102
  v_rcp_f32 v103, v103
  v_rcp_f32 v104, v104
  v_rcp_f32 v105, v105
  v_rcp_f32 v106, v106
  v_rcp_f32 v107, v107
  v_pk_mul_f32 v[100:101], v[100:101], v[180:181]
  v_pk_mul_f32 v[102:103], v[102:103], v[182:183]
  v_pk_mul_f32 v[104:105], v[104:105], v[184:185]
  v_pk_mul_f32 v[106:107], v[106:107], v[186:187]
  v_cvt_pk_bf16_f32 v176, v100, v101
  v_cvt_pk_bf16_f32 v177, v102, v103
  v_cvt_pk_bf16_f32 v178, v104, v105
  v_cvt_pk_bf16_f32 v179, v106, v107
  buffer_store_dwordx4 v[176:179], v51, s[32:35], s76 offen offset:1024 sc1
  v_add_u32 v66, 1, v66
  s_waitcnt vmcnt(15)
  buffer_store_dwordx2 v[66:67], v133, s[32:35], 0 offen offset:0 sc1
  v_pk_mul_f32 v[100:101], v[188:189], v[188:189]
  v_pk_mul_f32 v[102:103], v[190:191], v[190:191]
  v_pk_mul_f32 v[104:105], v[192:193], v[192:193]
  v_pk_mul_f32 v[106:107], v[194:195], v[194:195]
  v_pk_fma_f32 v[100:101], v[100:101], v[238:239], v[238:239] op_sel:[0,1,0] op_sel_hi:[1,1,0]
  v_pk_fma_f32 v[102:103], v[102:103], v[238:239], v[238:239] op_sel:[0,1,0] op_sel_hi:[1,1,0]
  v_pk_fma_f32 v[104:105], v[104:105], v[238:239], v[238:239] op_sel:[0,1,0] op_sel_hi:[1,1,0]
  v_pk_fma_f32 v[106:107], v[106:107], v[238:239], v[238:239] op_sel:[0,1,0] op_sel_hi:[1,1,0]
  v_pk_mul_f32 v[100:101], v[100:101], v[188:189]
  v_pk_mul_f32 v[102:103], v[102:103], v[190:191]
  v_pk_mul_f32 v[104:105], v[104:105], v[192:193]
  s_add_u32 m0, s66, 12288
  v_pk_mul_f32 v[106:107], v[106:107], v[194:195]
  buffer_load_dwordx4 v135, s[20:23], s81 offen lds
  v_exp_f32 v100, v100
  v_exp_f32 v101, v101
  v_exp_f32 v102, v102
  v_exp_f32 v103, v103
  v_exp_f32 v104, v104
  v_exp_f32 v105, v105
  v_exp_f32 v106, v106
  v_exp_f32 v107, v107
  v_pk_fma_f32 v[100:101], v[100:101], v[236:237], v[236:237] op_sel_hi:[1,0,0]
  v_pk_fma_f32 v[102:103], v[102:103], v[236:237], v[236:237] op_sel_hi:[1,0,0]
  v_pk_fma_f32 v[104:105], v[104:105], v[236:237], v[236:237] op_sel_hi:[1,0,0]
  v_pk_fma_f32 v[106:107], v[106:107], v[236:237], v[236:237] op_sel_hi:[1,0,0]
  v_rcp_f32 v100, v100
  v_rcp_f32 v101, v101
  v_rcp_f32 v102, v102
  v_rcp_f32 v103, v103
  v_rcp_f32 v104, v104
  v_rcp_f32 v105, v105
  v_rcp_f32 v106, v106
  v_rcp_f32 v107, v107
  s_add_u32 m0, s66, 16384
  s_add_u32 s70, s81, 16384
  buffer_load_dwordx4 v135, s[20:23], s70 offen lds
  v_pk_mul_f32 v[100:101], v[100:101], v[188:189]
  v_pk_mul_f32 v[102:103], v[102:103], v[190:191]
  v_pk_mul_f32 v[104:105], v[104:105], v[192:193]
  v_pk_mul_f32 v[106:107], v[106:107], v[194:195]
  v_cvt_pk_bf16_f32 v180, v100, v101
  v_cvt_pk_bf16_f32 v181, v102, v103
  v_cvt_pk_bf16_f32 v182, v104, v105
  v_cvt_pk_bf16_f32 v183, v106, v107
  buffer_store_dwordx4 v[180:183], v51, s[32:35], s76 offen offset:2048 sc1
  v_pk_mul_f32 v[100:101], v[196:197], v[196:197]
  v_pk_mul_f32 v[102:103], v[198:199], v[198:199]
  v_pk_mul_f32 v[104:105], v[200:201], v[200:201]
  v_pk_mul_f32 v[106:107], v[202:203], v[202:203]
  v_pk_fma_f32 v[100:101], v[100:101], v[238:239], v[238:239] op_sel:[0,1,0] op_sel_hi:[1,1,0]
  v_pk_fma_f32 v[102:103], v[102:103], v[238:239], v[238:239] op_sel:[0,1,0] op_sel_hi:[1,1,0]
  v_pk_fma_f32 v[104:105], v[104:105], v[238:239], v[238:239] op_sel:[0,1,0] op_sel_hi:[1,1,0]
  v_pk_fma_f32 v[106:107], v[106:107], v[238:239], v[238:239] op_sel:[0,1,0] op_sel_hi:[1,1,0]
  v_pk_mul_f32 v[100:101], v[100:101], v[196:197]
  v_pk_mul_f32 v[102:103], v[102:103], v[198:199]
  v_pk_mul_f32 v[104:105], v[104:105], v[200:201]
  v_pk_mul_f32 v[106:107], v[106:107], v[202:203]
  v_exp_f32 v100, v100
  v_exp_f32 v101, v101
  v_exp_f32 v102, v102
  v_exp_f32 v103, v103
  v_exp_f32 v104, v104
  v_exp_f32 v105, v105
  v_exp_f32 v106, v106
  v_exp_f32 v107, v107
  s_add_u32 m0, s66, 20480
  s_add_u32 s70, s81, 32768
  buffer_load_dwordx4 v135, s[20:23], s70 offen lds
  v_pk_fma_f32 v[100:101], v[100:101], v[236:237], v[236:237] op_sel_hi:[1,0,0]
  v_pk_fma_f32 v[102:103], v[102:103], v[236:237], v[236:237] op_sel_hi:[1,0,0]
  v_pk_fma_f32 v[104:105], v[104:105], v[236:237], v[236:237] op_sel_hi:[1,0,0]
  v_pk_fma_f32 v[106:107], v[106:107], v[236:237], v[236:237] op_sel_hi:[1,0,0]
  v_rcp_f32 v100, v100
  v_rcp_f32 v101, v101
  v_rcp_f32 v102, v102
  v_rcp_f32 v103, v103
  v_rcp_f32 v104, v104
  v_rcp_f32 v105, v105
  v_rcp_f32 v106, v106
  v_rcp_f32 v107, v107
  v_pk_mul_f32 v[100:101], v[100:101], v[196:197]
  v_pk_mul_f32 v[102:103], v[102:103], v[198:199]
  v_pk_mul_f32 v[104:105], v[104:105], v[200:201]
  v_pk_mul_f32 v[106:107], v[106:107], v[202:203]
  v_cvt_pk_bf16_f32 v184, v100, v101
  v_cvt_pk_bf16_f32 v185, v102, v103
  v_cvt_pk_bf16_f32 v186, v104, v105
  v_cvt_pk_bf16_f32 v187, v106, v107
  buffer_store_dwordx4 v[184:187], v51, s[32:35], s76 offen offset:3072 sc1
  v_mfma_f32_32x32x16_bf16 v[220:235], a[192:195], a[144:147], v[220:235]
  ds_read_b64_tr_b16 a[172:173], v98 offset:49152
  ds_read_b64_tr_b16 a[174:175], v98 offset:50176
  s_add_u32 m0, s66, 24576
  s_add_u32 s70, s81, 49152
  buffer_load_dwordx4 v135, s[20:23], s70 offen lds
  ds_read2_b64 v[100:103], v82 offset0:128 offset1:160
  ds_read2_b64 v[104:107], v82 offset0:192 offset1:224
  s_waitcnt lgkmcnt(8)
  v_mfma_f32_32x32x16_bf16 v[204:219], a[196:199], a[148:151], v[204:219]
  ds_read_b64_tr_b16 a[176:177], v99 offset:49152
  ds_read_b64_tr_b16 a[178:179], v99 offset:50176
  s_barrier
  v_mfma_f32_32x32x16_bf16 v[220:235], a[200:203], a[148:151], v[220:235]
  ds_read_b128 a[180:183], v254 offset:61440
  v_mfma_f32_32x32x16_bf16 v[204:219], a[204:207], a[152:155], v[204:219]
  ds_read_b128 a[184:187], v17 offset:61440
  s_add_u32 m0, s66, 28672
  s_add_u32 s70, s79, 65536
  buffer_load_dwordx4 v135, s[20:23], s70 offen lds
  s_waitcnt lgkmcnt(5)
  v_add_f32 v100, v100, v101
  v_add_f32 v102, v102, v103
  v_add_f32 v100, v100, v102
  v_mfma_f32_32x32x16_bf16 v[220:235], a[208:211], a[152:155], v[220:235]
  ds_read_b128 a[188:191], v255 offset:0
  s_waitcnt lgkmcnt(3)
  v_and_b32 v101, 0xffff0000, v100
  v_sub_f32 v102, v100, v101
  v_cvt_pk_bf16_f32 v76, v101, v102
  v_add_f32 v104, v104, v105
  v_add_f32 v106, v106, v107
  v_mfma_f32_32x32x16_bf16 v[204:219], a[164:167], a[156:159], v[204:219]
  ds_read_b128 a[192:195], v18 offset:0
  v_add_f32 v104, v104, v106
  v_and_b32 v105, 0xffff0000, v104
  v_sub_f32_e64 v106, v104, v105
  v_cvt_pk_bf16_f32 v78, v105, v106
  v_mfma_f32_32x32x16_bf16 v[220:235], a[168:171], a[156:159], v[220:235]
  ds_read_b128 a[196:199], v255 offset:4096
  s_add_u32 m0, s66, 32768
  s_add_u32 s70, s79, 81920
  buffer_load_dwordx4 v135, s[20:23], s70 offen lds
  v_mfma_f32_32x32x16_bf16 v[204:219], a[172:175], a[160:163], v[204:219]
  ds_read_b128 a[200:203], v18 offset:4096
  v_mfma_f32_32x32x16_bf16 v[220:235], a[176:179], a[160:163], v[220:235]
  ds_read_b128 a[204:207], v255 offset:8192
  s_nop 6
  v_mfma_f32_32x32x8_bf16 v[204:219], v[76:77], v[240:241], v[204:219]
  s_nop 0
  v_mfma_f32_32x32x8_bf16 v[220:235], v[78:79], v[240:241], v[220:235]
  s_add_u32 s76, s76, 4096
  s_nop 8
  v_pk_mul_f32 v[100:101], v[204:205], v[204:205]
  v_pk_mul_f32 v[102:103], v[206:207], v[206:207]
  v_pk_mul_f32 v[104:105], v[208:209], v[208:209]
  v_pk_mul_f32 v[106:107], v[210:211], v[210:211]
  v_pk_fma_f32 v[100:101], v[100:101], v[238:239], v[238:239] op_sel:[0,1,0] op_sel_hi:[1,1,0]
  v_pk_fma_f32 v[102:103], v[102:103], v[238:239], v[238:239] op_sel:[0,1,0] op_sel_hi:[1,1,0]
  v_pk_fma_f32 v[104:105], v[104:105], v[238:239], v[238:239] op_sel:[0,1,0] op_sel_hi:[1,1,0]
  v_pk_fma_f32 v[106:107], v[106:107], v[238:239], v[238:239] op_sel:[0,1,0] op_sel_hi:[1,1,0]
  v_pk_mul_f32 v[100:101], v[100:101], v[204:205]
  v_pk_mul_f32 v[102:103], v[102:103], v[206:207]
  v_pk_mul_f32 v[104:105], v[104:105], v[208:209]
  s_add_u32 m0, s66, 36864
  v_pk_mul_f32 v[106:107], v[106:107], v[210:211]
  buffer_load_dwordx4 v135, s[20:23], s83 offen lds
  v_exp_f32 v100, v100
  v_exp_f32 v101, v101
  v_exp_f32 v102, v102
  v_exp_f32 v103, v103
  v_exp_f32 v104, v104
  v_exp_f32 v105, v105
  v_exp_f32 v106, v106
  v_exp_f32 v107, v107
  v_pk_fma_f32 v[100:101], v[100:101], v[236:237], v[236:237] op_sel_hi:[1,0,0]
  v_pk_fma_f32 v[102:103], v[102:103], v[236:237], v[236:237] op_sel_hi:[1,0,0]
  v_pk_fma_f32 v[104:105], v[104:105], v[236:237], v[236:237] op_sel_hi:[1,0,0]
  v_pk_fma_f32 v[106:107], v[106:107], v[236:237], v[236:237] op_sel_hi:[1,0,0]
  v_rcp_f32 v100, v100
  v_rcp_f32 v101, v101
  v_rcp_f32 v102, v102
  v_rcp_f32 v103, v103
  v_rcp_f32 v104, v104
  v_rcp_f32 v105, v105
  v_rcp_f32 v106, v106
  v_rcp_f32 v107, v107
  s_add_u32 m0, s66, 40960
  s_add_u32 s70, s80, 65536
  buffer_load_dwordx4 v135, s[20:23], s70 offen lds
  v_pk_mul_f32 v[100:101], v[100:101], v[204:205]
  v_pk_mul_f32 v[102:103], v[102:103], v[206:207]
  v_pk_mul_f32 v[104:105], v[104:105], v[208:209]
  v_pk_mul_f32 v[106:107], v[106:107], v[210:211]
  v_cvt_pk_bf16_f32 v188, v100, v101
  v_cvt_pk_bf16_f32 v189, v102, v103
  v_cvt_pk_bf16_f32 v190, v104, v105
  v_cvt_pk_bf16_f32 v191, v106, v107
  buffer_store_dwordx4 v[188:191], v51, s[32:35], s76 offen offset:0 sc1
  v_pk_mul_f32 v[100:101], v[212:213], v[212:213]
  v_pk_mul_f32 v[102:103], v[214:215], v[214:215]
  v_pk_mul_f32 v[104:105], v[216:217], v[216:217]
  v_pk_mul_f32 v[106:107], v[218:219], v[218:219]
  v_pk_fma_f32 v[100:101], v[100:101], v[238:239], v[238:239] op_sel:[0,1,0] op_sel_hi:[1,1,0]
  v_pk_fma_f32 v[102:103], v[102:103], v[238:239], v[238:239] op_sel:[0,1,0] op_sel_hi:[1,1,0]
  v_pk_fma_f32 v[104:105], v[104:105], v[238:239], v[238:239] op_sel:[0,1,0] op_sel_hi:[1,1,0]
  v_pk_fma_f32 v[106:107], v[106:107], v[238:239], v[238:239] op_sel:[0,1,0] op_sel_hi:[1,1,0]
  v_pk_mul_f32 v[100:101], v[100:101], v[212:213]
  v_pk_mul_f32 v[102:103], v[102:103], v[214:215]
  v_pk_mul_f32 v[104:105], v[104:105], v[216:217]
  v_pk_mul_f32 v[106:107], v[106:107], v[218:219]
  v_exp_f32 v100, v100
  v_exp_f32 v101, v101
  v_exp_f32 v102, v102
  v_exp_f32 v103, v103
  v_exp_f32 v104, v104
  v_exp_f32 v105, v105
  v_exp_f32 v106, v106
  v_exp_f32 v107, v107
  s_add_u32 m0, s66, 45056
  s_add_u32 s70, s80, 81920
  buffer_load_dwordx4 v135, s[20:23], s70 offen lds
  v_pk_fma_f32 v[100:101], v[100:101], v[236:237], v[236:237] op_sel_hi:[1,0,0]
  v_pk_fma_f32 v[102:103], v[102:103], v[236:237], v[236:237] op_sel_hi:[1,0,0]
  v_pk_fma_f32 v[104:105], v[104:105], v[236:237], v[236:237] op_sel_hi:[1,0,0]
  v_pk_fma_f32 v[106:107], v[106:107], v[236:237], v[236:237] op_sel_hi:[1,0,0]
  v_rcp_f32 v100, v100
  v_rcp_f32 v101, v101
  v_rcp_f32 v102, v102
  v_rcp_f32 v103, v103
  v_rcp_f32 v104, v104
  v_rcp_f32 v105, v105
  v_rcp_f32 v106, v106
  v_rcp_f32 v107, v107
  v_pk_mul_f32 v[100:101], v[100:101], v[212:213]
  v_pk_mul_f32 v[102:103], v[102:103], v[214:215]
  v_pk_mul_f32 v[104:105], v[104:105], v[216:217]
  v_pk_mul_f32 v[106:107], v[106:107], v[218:219]
  v_cvt_pk_bf16_f32 v192, v100, v101
  v_cvt_pk_bf16_f32 v193, v102, v103
  v_cvt_pk_bf16_f32 v194, v104, v105
  v_cvt_pk_bf16_f32 v195, v106, v107
  buffer_store_dwordx4 v[192:195], v51, s[32:35], s76 offen offset:1024 sc1
  v_add_u32 v66, 1, v66
  s_waitcnt vmcnt(8)
  buffer_store_dwordx2 v[66:67], v133, s[32:35], 0 offen offset:128 sc1
  s_load_dwordx8 s[52:59], s[12:13], 0 glc
  v_pk_mul_f32 v[100:101], v[220:221], v[220:221]
  v_pk_mul_f32 v[102:103], v[222:223], v[222:223]
  v_pk_mul_f32 v[104:105], v[224:225], v[224:225]
  v_pk_mul_f32 v[106:107], v[226:227], v[226:227]
  v_pk_fma_f32 v[100:101], v[100:101], v[238:239], v[238:239] op_sel:[0,1,0] op_sel_hi:[1,1,0]
  v_pk_fma_f32 v[102:103], v[102:103], v[238:239], v[238:239] op_sel:[0,1,0] op_sel_hi:[1,1,0]
  v_pk_fma_f32 v[104:105], v[104:105], v[238:239], v[238:239] op_sel:[0,1,0] op_sel_hi:[1,1,0]
  v_pk_fma_f32 v[106:107], v[106:107], v[238:239], v[238:239] op_sel:[0,1,0] op_sel_hi:[1,1,0]
  v_pk_mul_f32 v[100:101], v[100:101], v[220:221]
  v_pk_mul_f32 v[102:103], v[102:103], v[222:223]
  v_pk_mul_f32 v[104:105], v[104:105], v[224:225]
  v_pk_mul_f32 v[106:107], v[106:107], v[226:227]
  v_exp_f32 v100, v100
  v_exp_f32 v101, v101
  v_exp_f32 v102, v102
  v_exp_f32 v103, v103
  v_exp_f32 v104, v104
  v_exp_f32 v105, v105
  v_exp_f32 v106, v106
  v_exp_f32 v107, v107
  v_pk_fma_f32 v[100:101], v[100:101], v[236:237], v[236:237] op_sel_hi:[1,0,0]
  v_pk_fma_f32 v[102:103], v[102:103], v[236:237], v[236:237] op_sel_hi:[1,0,0]
  v_pk_fma_f32 v[104:105], v[104:105], v[236:237], v[236:237] op_sel_hi:[1,0,0]
  v_pk_fma_f32 v[106:107], v[106:107], v[236:237], v[236:237] op_sel_hi:[1,0,0]
  v_rcp_f32 v100, v100
  v_rcp_f32 v101, v101
  v_rcp_f32 v102, v102
  v_rcp_f32 v103, v103
  v_rcp_f32 v104, v104
  v_rcp_f32 v105, v105
  v_rcp_f32 v106, v106
  v_rcp_f32 v107, v107
  v_pk_mul_f32 v[100:101], v[100:101], v[220:221]
  v_pk_mul_f32 v[102:103], v[102:103], v[222:223]
  v_pk_mul_f32 v[104:105], v[104:105], v[224:225]
  v_pk_mul_f32 v[106:107], v[106:107], v[226:227]
  v_cvt_pk_bf16_f32 v196, v100, v101
  v_cvt_pk_bf16_f32 v197, v102, v103
  v_cvt_pk_bf16_f32 v198, v104, v105
  v_cvt_pk_bf16_f32 v199, v106, v107
  buffer_store_dwordx4 v[196:199], v51, s[32:35], s76 offen offset:2048 sc1
  s_waitcnt vmcnt(9)
  s_barrier
  s_waitcnt lgkmcnt(3)
  v_mfma_f32_32x32x16_bf16 v[140:155], a[180:183], v[244:247], 0
  s_add_u32 m0, s66, 49152
  ds_read_b128 a[208:211], v18 offset:8192
  buffer_load_dwordx4 v135, s[20:23], s84 offen lds
  s_lshl2_add_u32 s73, s60, s64
  v_mfma_f32_32x32x16_bf16 v[140:155], a[184:187], v[248:251], v[140:155]
  ds_read_b128 a[164:167], v254 offset:20480
  s_mul_i32 s74, s73, 114688
  s_add_u32 s74, s74, 16777216
  v_lshl_add_u32 v22, v1, 4, s74
  s_add_u32 s74, s74, 2560
  v_mfma_f32_32x32x16_bf16 v[156:171], a[188:191], v[244:247], 0
  ds_read_b128 a[168:171], v17 offset:20480
  s_add_u32 m0, s66, 53248
  s_add_u32 s70, s81, 65536
  buffer_load_dwordx4 v135, s[20:23], s70 offen lds
  v_lshl_add_u32 v25, v1, 2, s74
  v_mfma_f32_32x32x16_bf16 v[156:171], a[192:195], v[248:251], v[156:171]
  ds_read_b128 a[172:175], v254 offset:24576
  s_waitcnt lgkmcnt(3)
  s_lshl_b32 s73, s73, 16
  s_lshl_b32 s74, s71, 7
  s_add_u32 s73, s73, s74
  v_mfma_f32_32x32x16_bf16 v[108:123], a[196:199], v[244:247], 0
  ds_read_b128 a[176:179], v17 offset:24576
  s_add_u32 m0, s66, 57344
  s_add_u32 s70, s81, 81920
  buffer_load_dwordx4 v135, s[20:23], s70 offen lds
  v_lshl_add_u32 v11, v2, 2, s73
  v_mfma_f32_32x32x16_bf16 v[108:123], a[200:203], v[248:251], v[108:123]
  ds_read_b64_tr_b16 a[180:181], v50 offset:40960
  ds_read_b64_tr_b16 a[182:183], v50 offset:43008
  v_lshl_add_u32 v23, v3, 15, v11
  v_add_u32 v24, 16384, v23
  s_movk_i32 s90, 4096
  v_mfma_f32_32x32x16_bf16 v[140:155], a[204:207], v[124:127], v[140:155]
  ds_read_b64_tr_b16 a[184:185], v242 offset:40960
  s_add_u32 m0, s66, 61440
  ds_read_b64_tr_b16 a[186:187], v242 offset:43008
  buffer_load_dwordx4 v135, s[20:23], s85 offen lds
  s_movk_i32 s91, 8192
  v_mfma_f32_32x32x16_bf16 v[140:155], a[208:211], v[128:131], v[140:155]
  ds_read_b64_tr_b16 a[188:189], v46 offset:40960
  ds_read_b64_tr_b16 a[190:191], v46 offset:43008
  s_waitcnt lgkmcnt(6)
  s_movk_i32 s92, 12288
  v_and_b32 v11, 1, v1
  v_mfma_f32_32x32x16_bf16 v[156:171], a[164:167], v[124:127], v[156:171]
  ds_read_b64_tr_b16 a[192:193], v50 offset:45056
  s_add_u32 m0, s66, 155648
  ds_read_b64_tr_b16 a[194:195], v50 offset:47104
  buffer_load_dwordx4 v26, s[28:31], s87 offen lds
  v_lshlrev_b32 v11, 4, v11
  v_mfma_f32_32x32x16_bf16 v[156:171], a[168:171], v[128:131], v[156:171]
  ds_read_b64_tr_b16 a[196:197], v242 offset:45056
  ds_read_b64_tr_b16 a[198:199], v242 offset:47104
  v_lshlrev_b32 v12, v11, v54
  v_mov_b32 v13, 0x3f80
  v_lshlrev_b32 v14, 2, v3
  v_mfma_f32_32x32x16_bf16 v[108:123], a[172:175], v[124:127], v[108:123]
  ds_read_b64_tr_b16 a[200:201], v46 offset:45056
  s_add_u32 m0, s66, 159744
  ds_read_b64_tr_b16 a[202:203], v46 offset:47104
  buffer_load_dwordx4 v26, s[28:31], s88 offen lds
  v_sub_u32 v14, v2, v14
  v_mfma_f32_32x32x16_bf16 v[108:123], a[176:179], v[128:131], v[108:123]
  ds_read_b64_tr_b16 a[204:205], v50 offset:49152
  ds_read_b64_tr_b16 a[206:207], v50 offset:51200
  s_waitcnt lgkmcnt(6)
  v_and_b32 v14, -2, v14
  v_cmp_eq_u32 s[48:49], 0, v3
  v_mfma_f32_32x32x16_bf16 v[140:155], a[180:183], v[172:175], v[140:155]
  ds_read_b64_tr_b16 a[208:209], v242 offset:49152
  ds_read_b64_tr_b16 a[210:211], v242 offset:51200
  s_add_u32 s50, s50, 1
  s_waitcnt lgkmcnt(0)
  s_xor_b64 s[40:41], s[52:53], s[50:51]
  s_xor_b64 s[16:17], s[54:55], s[50:51]
  s_or_b64 s[40:41], s[40:41], s[16:17]
  s_xor_b64 s[16:17], s[56:57], s[50:51]
  s_or_b64 s[40:41], s[40:41], s[16:17]
  s_xor_b64 s[16:17], s[58:59], s[50:51]
  s_or_b64 s[40:41], s[40:41], s[16:17]
  s_cbranch_scc1 L_sp4
L_ok4:
  v_mfma_f32_32x32x16_bf16 v[156:171], a[184:187], v[172:175], v[156:171]
  ds_read_b64_tr_b16 a[164:165], v46 offset:49152
  ds_read_b64_tr_b16 a[166:167], v46 offset:51200
  s_add_u32 s77, s44, 7168
  buffer_load_dwordx4 a[216:219], v51, s[32:35], s77 offen offset:0 sc1
  v_mul_f32 v15, v138, v139
  v_mfma_f32_32x32x16_bf16 v[108:123], a[188:191], v[172:175], v[108:123]
  ds_read_b64_tr_b16 a[168:169], v50 offset:53248
  ds_read_b64_tr_b16 a[170:171], v50 offset:55296
  v_mov_b32 v241, 0
  v_cndmask_b32 v240, 0, v13, s[48:49]
  v_cmp_eq_u32 s[48:49], 0, v14
  v_mfma_f32_32x32x16_bf16 v[140:155], a[192:195], v[176:179], v[140:155]
  ds_read_b64_tr_b16 a[172:173], v242 offset:53248
  ds_read_b64_tr_b16 a[174:175], v242 offset:55296
  buffer_load_dwordx4 a[228:231], v51, s[32:35], s77 offen offset:1024 sc1
  v_accvgpr_read_b32 v16, a4
  v_mfma_f32_32x32x16_bf16 v[156:171], a[196:199], v[176:179], v[156:171]
  ds_read_b64_tr_b16 a[176:177], v46 offset:53248
  ds_read_b64_tr_b16 a[178:179], v46 offset:55296
  v_lshlrev_b32 v13, 16, v16
  v_and_b32 v16, 0xffff0000, v16
  v_cndmask_b32 v84, 0, v12, s[48:49]
  v_mfma_f32_32x32x16_bf16 v[108:123], a[200:203], v[176:179], v[108:123]
  ds_read_b64_tr_b16 a[180:181], v50 offset:0
  ds_read_b64_tr_b16 a[182:183], v50 offset:2048
  buffer_load_dwordx4 a[240:243], v51, s[32:35], s77 offen offset:2048 sc1
  v_sub_f32 v13, v13, v138
  v_sub_f32 v16, v16, v138
  v_mfma_f32_32x32x16_bf16 v[140:155], a[204:207], v[180:183], v[140:155]
  ds_read_b64_tr_b16 a[184:185], v242 offset:0
  ds_read_b64_tr_b16 a[186:187], v242 offset:2048
  v_cvt_pk_bf16_f32 v16, v13, v16
  v_lshlrev_b32 v13, 16, v16
  v_and_b32 v16, 0xffff0000, v16
  v_mfma_f32_32x32x16_bf16 v[156:171], a[208:211], v[180:183], v[156:171]
  ds_read_b64_tr_b16 a[188:189], v46 offset:0
  ds_read_b64_tr_b16 a[190:191], v46 offset:2048
  s_waitcnt lgkmcnt(6)
  buffer_load_dwordx4 a[252:255], v51, s[32:35], s77 offen offset:3072 sc1
  v_mul_f32 v13, v13, v139
  v_mfma_f32_32x32x16_bf16 v[108:123], a[164:167], v[180:183], v[108:123]
  ds_read_b64_tr_b16 a[192:193], v50 offset:4096
  ds_read_b64_tr_b16 a[194:195], v50 offset:6144
  v_mul_f32 v16, v16, v139
  v_cvt_pk_bf16_f32 v92, v13, v16
  v_cmp_eq_u32 s[48:49], 2, v14
  v_mfma_f32_32x32x16_bf16 v[140:155], a[168:171], v[184:187], v[140:155]
  ds_read_b64_tr_b16 a[196:197], v242 offset:4096
  ds_read_b64_tr_b16 a[198:199], v242 offset:6144
  s_add_u32 s77, s45, 7168
  buffer_load_dwordx4 a[220:223], v51, s[32:35], s77 offen offset:0 sc1
  v_accvgpr_read_b32 v16, a5
  v_mfma_f32_32x32x16_bf16 v[156:171], a[172:175], v[184:187], v[156:171]
  ds_read_b64_tr_b16 a[200:201], v46 offset:4096
  ds_read_b64_tr_b16 a[202:203], v46 offset:6144
  s_load_dwordx8 s[52:59], s[12:13], 128 glc
  v_lshlrev_b32 v13, 16, v16
  v_and_b32 v16, 0xffff0000, v16
  v_mfma_f32_32x32x16_bf16 v[108:123], a[176:179], v[184:187], v[108:123]
  ds_read_b64_tr_b16 a[204:205], v50 offset:8192
  ds_read_b64_tr_b16 a[206:207], v50 offset:10240
  s_waitcnt lgkmcnt(6)
  buffer_load_dwordx4 a[232:235], v51, s[32:35], s77 offen offset:1024 sc1
  v_cndmask_b32 v85, 0, v12, s[48:49]
  v_mfma_f32_32x32x16_bf16 v[140:155], a[180:183], v[188:191], v[140:155]
  ds_read_b64_tr_b16 a[208:209], v242 offset:8192
  ds_read_b64_tr_b16 a[210:211], v242 offset:10240
  v_sub_f32 v13, v13, v138
  v_sub_f32 v16, v16, v138
  v_cvt_pk_bf16_f32 v16, v13, v16
  v_mfma_f32_32x32x16_bf16 v[156:171], a[184:187], v[188:191], v[156:171]
  ds_read_b64_tr_b16 a[164:165], v46 offset:8192
  ds_read_b64_tr_b16 a[166:167], v46 offset:10240
  buffer_load_dwordx4 a[244:247], v51, s[32:35], s77 offen offset:2048 sc1
  v_lshlrev_b32 v13, 16, v16
  v_and_b32 v16, 0xffff0000, v16
  v_mfma_f32_32x32x16_bf16 v[108:123], a[188:191], v[188:191], v[108:123]
  ds_read_b128 a[168:171], v19 offset:61440
  v_mul_f32 v13, v13, v139
  v_mul_f32 v16, v16, v139
  v_cvt_pk_bf16_f32 v93, v13, v16
  v_cmp_eq_u32 s[48:49], 8, v14
  v_mfma_f32_32x32x16_bf16 v[140:155], a[192:195], v[192:195], v[140:155]
  ds_read_b128 a[172:175], v20 offset:0
  s_waitcnt lgkmcnt(4)
  buffer_load_dwordx4 a[36:39], v51, s[32:35], s77 offen offset:3072 sc1
  v_accvgpr_read_b32 v16, a6
  v_lshlrev_b32 v13, 16, v16
  v_mfma_f32_32x32x16_bf16 v[156:171], a[196:199], v[192:195], v[156:171]
  ds_read_b128 a[176:179], v20 offset:4096
  v_add_u32 v66, 1, v66
  s_waitcnt vmcnt(14)
  buffer_store_dwordx2 v[66:67], v133, s[32:35], 0 offen offset:256 sc1
  v_and_b32 v16, 0xffff0000, v16
  v_mfma_f32_32x32x16_bf16 v[108:123], a[200:203], v[192:195], v[108:123]
  ds_read_b128 a[180:183], v21 offset:61440
  s_add_u32 s77, s46, 7168
  buffer_load_dwordx4 a[224:227], v51, s[32:35], s77 offen offset:0 sc1
  v_cndmask_b32 v86, 0, v12, s[48:49]
  v_sub_f32 v13, v13, v138
  v_mfma_f32_32x32x16_bf16 v[140:155], a[204:207], v[196:199], v[140:155]
  ds_read_b128 a[184:187], v57 offset:0
  v_sub_f32 v16, v16, v138
  v_cvt_pk_bf16_f32 v16, v13, v16
  v_lshlrev_b32 v13, 16, v16
  v_and_b32 v16, 0xffff0000, v16
  v_mfma_f32_32x32x16_bf16 v[156:171], a[208:211], v[196:199], v[156:171]
  ds_read_b128 a[188:191], v57 offset:4096
  s_waitcnt lgkmcnt(3)
  buffer_load_dwordx4 a[236:239], v51, s[32:35], s77 offen offset:1024 sc1
  v_mul_f32 v13, v13, v139
  v_mul_f32 v16, v16, v139
  v_mfma_f32_32x32x16_bf16 v[108:123], a[164:167], v[196:199], v[108:123]
  ds_read_b128 a[192:195], v20 offset:8192
  v_cvt_pk_bf16_f32 v94, v13, v16
  v_cmp_eq_u32 s[48:49], 10, v14
  v_accvgpr_read_b32 v16, a7
  v_lshlrev_b32 v13, 16, v16
  s_waitcnt vmcnt(10)
  v_mfma_f32_32x32x16_bf16 v[140:155], a[168:171], a[216:219], v[140:155]
  ds_read_b128 a[196:199], v57 offset:8192
  buffer_load_dwordx4 a[248:251], v51, s[32:35], s77 offen offset:2048 sc1
  v_and_b32 v16, 0xffff0000, v16
  v_cndmask_b32 v87, 0, v12, s[48:49]
  v_sub_f32 v13, v13, v138
  v_mfma_f32_32x32x16_bf16 v[156:171], a[172:175], a[216:219], v[156:171]
  ds_read_b128 a[200:203], v254 offset:0
  v_sub_f32 v16, v16, v138
  v_cvt_pk_bf16_f32 v16, v13, v16
  v_lshlrev_b32 v13, 16, v16
  v_and_b32 v16, 0xffff0000, v16
  v_mfma_f32_32x32x16_bf16 v[108:123], a[176:179], a[216:219], v[108:123]
  ds_read_b128 a[204:207], v254 offset:49152
  s_waitcnt lgkmcnt(3)
  buffer_load_dwordx4 a[40:43], v51, s[32:35], s77 offen offset:3072 sc1
  v_mul_f32 v13, v13, v139
  v_mul_f32 v16, v16, v139
  s_waitcnt vmcnt(11)
  v_mfma_f32_32x32x16_bf16 v[140:155], a[180:183], a[228:231], v[140:155]
  ds_read_b128 a[208:211], v254 offset:4096
  s_add_u32 s50, s50, 1
  s_waitcnt lgkmcnt(0)
  s_xor_b64 s[40:41], s[52:53], s[50:51]
  s_xor_b64 s[16:17], s[54:55], s[50:51]
  s_or_b64 s[40:41], s[40:41], s[16:17]
  s_xor_b64 s[16:17], s[56:57], s[50:51]
  s_or_b64 s[40:41], s[40:41], s[16:17]
  s_xor_b64 s[16:17], s[58:59], s[50:51]
  s_or_b64 s[40:41], s[40:41], s[16:17]
  s_cbranch_scc1 L_sp5
L_ok5:
  v_mfma_f32_32x32x16_bf16 v[156:171], a[184:187], a[228:231], v[156:171]
  ds_read_b128 a[164:167], v17 offset:0
  buffer_load_dwordx4 a[44:47], v51, s[32:35], s44 offen offset:0 sc1
  v_cvt_pk_bf16_f32 v95, v13, v16
  v_cmp_eq_u32 s[48:49], 16, v14
  v_accvgpr_read_b32 v16, a8
  v_mfma_f32_32x32x16_bf16 v[108:123], a[188:191], a[228:231], v[108:123]
  ds_read_b128 a[168:171], v17 offset:49152
  v_lshlrev_b32 v13, 16, v16
  v_and_b32 v16, 0xffff0000, v16
  v_cndmask_b32 v88, 0, v12, s[48:49]
  v_sub_f32 v13, v13, v138
  s_waitcnt vmcnt(11)
  v_mfma_f32_32x32x16_bf16 v[140:155], a[192:195], a[240:243], v[140:155]
  ds_read_b128 a[172:175], v17 offset:4096
  buffer_load_dwordx4 a[56:59], v51, s[32:35], s44 offen offset:1024 sc1
  v_sub_f32 v16, v16, v138
  v_cvt_pk_bf16_f32 v16, v13, v16
  s_waitcnt vmcnt(11)
  v_mfma_f32_32x32x16_bf16 v[140:155], a[196:199], a[252:255], v[140:155]
  ds_read_b128 a[176:179], v254 offset:45056
  v_lshlrev_b32 v13, 16, v16
  v_and_b32 v16, 0xffff0000, v16
  v_mul_f32 v13, v13, v139
  v_mul_f32 v16, v16, v139
  s_waitcnt vmcnt(10)
  v_mfma_f32_32x32x16_bf16 v[140:155], a[200:203], a[220:223], v[140:155]
  ds_read_b128 a[180:183], v17 offset:45056
  buffer_load_dwordx4 a[68:71], v51, s[32:35], s44 offen offset:2048 sc1
  v_cvt_pk_bf16_f32 v96, v13, v16
  v_cmp_eq_u32 s[48:49], 18, v14
  v_accvgpr_read_b32 v16, a9
  v_mfma_f32_32x32x16_bf16 v[156:171], a[204:207], a[220:223], v[156:171]
  ds_read_b128 a[184:187], v19 offset:0
  v_lshlrev_b32 v13, 16, v16
  v_and_b32 v16, 0xffff0000, v16
  v_cndmask_b32 v89, 0, v12, s[48:49]
  v_sub_f32 v13, v13, v138
  v_mfma_f32_32x32x16_bf16 v[108:123], a[208:211], a[220:223], v[108:123]
  ds_read_b128 a[188:191], v19 offset:49152
  s_waitcnt lgkmcnt(3)
  buffer_load_dwordx4 a[80:83], v51, s[32:35], s44 offen offset:3072 sc1
  v_sub_f32 v16, v16, v138
  v_cvt_pk_bf16_f32 v16, v13, v16
  s_waitcnt vmcnt(11)
  v_mfma_f32_32x32x16_bf16 v[140:155], a[164:167], a[232:235], v[140:155]
  ds_read_b128 a[192:195], v21 offset:0
  v_lshlrev_b32 v13, 16, v16
  v_and_b32 v16, 0xffff0000, v16
  v_mul_f32 v13, v13, v139
  v_mul_f32 v16, v16, v139
  v_mfma_f32_32x32x16_bf16 v[156:171], a[168:171], a[232:235], v[156:171]
  ds_read_b128 a[196:199], v21 offset:49152
  buffer_load_dwordx4 a[48:51], v51, s[32:35], s45 offen offset:0 sc1
  v_cvt_pk_bf16_f32 v97, v13, v16
  v_cmp_eq_u32 s[48:49], 24, v14
  v_accvgpr_read_b32 v16, a10
  v_mfma_f32_32x32x16_bf16 v[108:123], a[172:175], a[232:235], v[108:123]
  ds_read_b128 a[200:203], v19 offset:45056
  v_lshlrev_b32 v13, 16, v16
  v_and_b32 v16, 0xffff0000, v16
  v_cndmask_b32 v90, 0, v12, s[48:49]
  v_sub_f32 v13, v13, v138
  s_waitcnt vmcnt(11)
  v_mfma_f32_32x32x16_bf16 v[140:155], a[176:179], a[244:247], v[140:155]
  ds_read_b128 a[204:207], v21 offset:45056
  s_waitcnt lgkmcnt(3)
  buffer_load_dwordx4 a[60:63], v51, s[32:35], s45 offen offset:1024 sc1
  v_sub_f32 v16, v16, v138
  v_cvt_pk_bf16_f32 v16, v13, v16
  s_waitcnt vmcnt(11)
  v_mfma_f32_32x32x16_bf16 v[140:155], a[180:183], a[36:39], v[140:155]
  ds_read_b64_tr_b16 a[208:209], v50 offset:20480
  ds_read_b64_tr_b16 a[210:211], v50 offset:22528
  v_lshlrev_b32 v13, 16, v16
  v_and_b32 v16, 0xffff0000, v16
  v_mul_f32 v13, v13, v139
  s_waitcnt vmcnt(9)
  v_mfma_f32_32x32x16_bf16 v[140:155], a[184:187], a[224:227], v[140:155]
  ds_read_b64_tr_b16 a[164:165], v242 offset:20480
  ds_read_b64_tr_b16 a[166:167], v242 offset:22528
  buffer_load_dwordx4 a[72:75], v51, s[32:35], s45 offen offset:2048 sc1
  v_mul_f32 v16, v16, v139
  v_cvt_pk_bf16_f32 v98, v13, v16
  v_mfma_f32_32x32x16_bf16 v[156:171], a[188:191], a[224:227], v[156:171]
  ds_read_b64_tr_b16 a[168:169], v46 offset:20480
  ds_read_b64_tr_b16 a[170:171], v46 offset:22528
  s_load_dwordx8 s[52:59], s[12:13], 256 glc
  v_cmp_eq_u32 s[48:49], 26, v14
  v_accvgpr_read_b32 v16, a11
  s_waitcnt vmcnt(9)
  v_mfma_f32_32x32x16_bf16 v[140:155], a[192:195], a[236:239], v[140:155]
  ds_read_b64_tr_b16 a[172:173], v50 offset:24576
  ds_read_b64_tr_b16 a[174:175], v50 offset:26624
  s_waitcnt lgkmcnt(6)
  buffer_load_dwordx4 a[84:87], v51, s[32:35], s45 offen offset:3072 sc1
  v_lshlrev_b32 v13, 16, v16
  v_mfma_f32_32x32x16_bf16 v[156:171], a[196:199], a[236:239], v[156:171]
  ds_read_b64_tr_b16 a[176:177], v242 offset:24576
  ds_read_b64_tr_b16 a[178:179], v242 offset:26624
  v_and_b32 v16, 0xffff0000, v16
  v_cndmask_b32 v91, 0, v12, s[48:49]
  v_sub_f32 v13, v13, v138
  s_waitcnt vmcnt(9)
  v_mfma_f32_32x32x16_bf16 v[140:155], a[200:203], a[248:251], v[140:155]
  ds_read_b64_tr_b16 a[180:181], v46 offset:24576
  ds_read_b64_tr_b16 a[182:183], v46 offset:26624
  buffer_load_dwordx4 a[52:55], v51, s[32:35], s46 offen offset:0 sc1
  v_sub_f32 v16, v16, v138
  v_cvt_pk_bf16_f32 v16, v13, v16
  s_waitcnt vmcnt(9)
  v_mfma_f32_32x32x16_bf16 v[140:155], a[204:207], a[40:43], v[140:155]
  ds_read_b64_tr_b16 a[184:185], v50 offset:28672
  ds_read_b64_tr_b16 a[186:187], v50 offset:30720
  v_lshlrev_b32 v13, 16, v16
  v_and_b32 v16, 0xffff0000, v16
  v_mul_f32 v13, v13, v139
  s_waitcnt vmcnt(8)
  v_mfma_f32_32x32x16_bf16 v[140:155], a[208:211], a[44:47], v[140:155]
  ds_read_b64_tr_b16 a[188:189], v242 offset:28672
  ds_read_b64_tr_b16 a[190:191], v242 offset:30720
  s_waitcnt lgkmcnt(6)
  buffer_load_dwordx4 a[64:67], v51, s[32:35], s46 offen offset:1024 sc1
  v_mul_f32 v16, v16, v139
  v_mfma_f32_32x32x16_bf16 v[156:171], a[164:167], a[44:47], v[156:171]
  ds_read_b64_tr_b16 a[192:193], v46 offset:28672
  ds_read_b64_tr_b16 a[194:195], v46 offset:30720
  v_cvt_pk_bf16_f32 v99, v13, v16
  v_mfma_f32_32x32x16_bf16 v[108:123], a[168:171], a[44:47], v[108:123]
  ds_read_b64_tr_b16 a[196:197], v52 offset:0
  ds_read_b64_tr_b16 a[198:199], v52 offset:2048
  buffer_load_dwordx4 a[76:79], v51, s[32:35], s46 offen offset:2048 sc1
  s_waitcnt vmcnt(9)
  v_mfma_f32_32x32x16_bf16 v[140:155], a[172:175], a[56:59], v[140:155]
  ds_read_b64_tr_b16 a[200:201], v243 offset:0
  ds_read_b64_tr_b16 a[202:203], v243 offset:2048
  v_mfma_f32_32x32x16_bf16 v[156:171], a[176:179], a[56:59], v[156:171]
  ds_read_b64_tr_b16 a[204:205], v47 offset:0
  ds_read_b64_tr_b16 a[206:207], v47 offset:2048
  s_waitcnt lgkmcnt(6)
  buffer_load_dwordx4 a[88:91], v51, s[32:35], s46 offen offset:3072 sc1
  v_mfma_f32_32x32x16_bf16 v[108:123], a[180:183], a[56:59], v[108:123]
  ds_read_b64_tr_b16 a[208:209], v52 offset:4096
  ds_read_b64_tr_b16 a[210:211], v52 offset:6144
  s_waitcnt vmcnt(9)
  v_mfma_f32_32x32x16_bf16 v[140:155], a[184:187], a[68:71], v[140:155]
  ds_read_b64_tr_b16 a[164:165], v243 offset:4096
  ds_read_b64_tr_b16 a[166:167], v243 offset:6144
  v_mfma_f32_32x32x16_bf16 v[156:171], a[188:191], a[68:71], v[156:171]
  ds_read_b64_tr_b16 a[168:169], v47 offset:4096
  ds_read_b64_tr_b16 a[170:171], v47 offset:6144
  v_mfma_f32_32x32x16_bf16 v[108:123], a[192:195], a[68:71], v[108:123]
  ds_read_b64_tr_b16 a[172:173], v27 offset:0
  ds_read_b64_tr_b16 a[174:175], v27 offset:2048
  s_waitcnt lgkmcnt(6) vmcnt(8)
  v_mfma_f32_32x32x16_bf16 v[140:155], a[196:199], a[80:83], v[140:155]
  ds_read_b64_tr_b16 a[176:177], v53 offset:0
  ds_read_b64_tr_b16 a[178:179], v53 offset:2048
  s_add_u32 s50, s50, 1
  s_waitcnt lgkmcnt(0)
  s_xor_b64 s[40:41], s[52:53], s[50:51]
  s_xor_b64 s[16:17], s[54:55], s[50:51]
  s_or_b64 s[40:41], s[40:41], s[16:17]
  s_xor_b64 s[16:17], s[56:57], s[50:51]
  s_or_b64 s[40:41], s[40:41], s[16:17]
  s_xor_b64 s[16:17], s[58:59], s[50:51]
  s_or_b64 s[40:41], s[40:41], s[16:17]
  s_cbranch_scc1 L_sp6
L_ok6:
  v_mfma_f32_32x32x16_bf16 v[156:171], a[200:203], a[80:83], v[156:171]
  ds_read_b64_tr_b16 a[180:181], v45 offset:0
  ds_read_b64_tr_b16 a[182:183], v45 offset:2048
  s_add_u32 s77, s44, 4096
  buffer_load_dwordx4 a[92:95], v51, s[32:35], s77 offen offset:0 sc1
  v_mfma_f32_32x32x16_bf16 v[108:123], a[204:207], a[80:83], v[108:123]
  ds_read_b64_tr_b16 a[184:185], v27 offset:4096
  ds_read_b64_tr_b16 a[186:187], v27 offset:6144
  s_waitcnt vmcnt(8)
  v_mfma_f32_32x32x16_bf16 v[140:155], a[208:211], a[48:51], v[140:155]
  ds_read_b64_tr_b16 a[188:189], v53 offset:4096
  ds_read_b64_tr_b16 a[190:191], v53 offset:6144
  buffer_load_dwordx4 a[104:107], v51, s[32:35], s77 offen offset:1024 sc1
  v_mfma_f32_32x32x16_bf16 v[156:171], a[164:167], a[48:51], v[156:171]
  ds_read_b64_tr_b16 a[192:193], v45 offset:4096
  ds_read_b64_tr_b16 a[194:195], v45 offset:6144
  v_mfma_f32_32x32x16_bf16 v[108:123], a[168:171], a[48:51], v[108:123]
  ds_read_b64_tr_b16 a[196:197], v27 offset:8192
  ds_read_b64_tr_b16 a[198:199], v27 offset:10240
  buffer_load_dwordx4 a[116:119], v51, s[32:35], s77 offen offset:2048 sc1
  s_waitcnt vmcnt(9)
  v_mfma_f32_32x32x16_bf16 v[140:155], a[172:175], a[60:63], v[140:155]
  ds_read_b64_tr_b16 a[200:201], v53 offset:8192
  ds_read_b64_tr_b16 a[202:203], v53 offset:10240
  v_mfma_f32_32x32x16_bf16 v[156:171], a[176:179], a[60:63], v[156:171]
  ds_read_b64_tr_b16 a[204:205], v45 offset:8192
  ds_read_b64_tr_b16 a[206:207], v45 offset:10240
  s_waitcnt lgkmcnt(6)
  s_add_u32 s77, s45, 4096
  buffer_load_dwordx4 a[96:99], v51, s[32:35], s77 offen offset:0 sc1
  v_mfma_f32_32x32x16_bf16 v[108:123], a[180:183], a[60:63], v[108:123]
  ds_read_b64_tr_b16 a[208:209], v27 offset:12288
  ds_read_b64_tr_b16 a[210:211], v27 offset:14336
  s_waitcnt vmcnt(9)
  v_mfma_f32_32x32x16_bf16 v[140:155], a[184:187], a[72:75], v[140:155]
  ds_read_b64_tr_b16 a[164:165], v53 offset:12288
  ds_read_b64_tr_b16 a[166:167], v53 offset:14336
  buffer_load_dwordx4 a[108:111], v51, s[32:35], s77 offen offset:1024 sc1
  v_mfma_f32_32x32x16_bf16 v[156:171], a[188:191], a[72:75], v[156:171]
  ds_read_b64_tr_b16 a[168:169], v45 offset:12288
  ds_read_b64_tr_b16 a[170:171], v45 offset:14336
  v_mfma_f32_32x32x16_bf16 v[108:123], a[192:195], a[72:75], v[108:123]
  ds_read_b64_tr_b16 a[172:173], v27 offset:16384
  ds_read_b64_tr_b16 a[174:175], v27 offset:18432
  s_waitcnt lgkmcnt(6)
  buffer_load_dwordx4 a[120:123], v51, s[32:35], s77 offen offset:2048 sc1
  s_waitcnt vmcnt(10)
  v_mfma_f32_32x32x16_bf16 v[140:155], a[196:199], a[84:87], v[140:155]
  ds_read_b64_tr_b16 a[176:177], v53 offset:16384
  ds_read_b64_tr_b16 a[178:179], v53 offset:18432
  v_mfma_f32_32x32x16_bf16 v[156:171], a[200:203], a[84:87], v[156:171]
  ds_read_b64_tr_b16 a[180:181], v45 offset:16384
  ds_read_b64_tr_b16 a[182:183], v45 offset:18432
  s_add_u32 s77, s46, 4096
  buffer_load_dwordx4 a[100:103], v51, s[32:35], s77 offen offset:0 sc1
  v_mfma_f32_32x32x16_bf16 v[108:123], a[204:207], a[84:87], v[108:123]
  ds_read_b64_tr_b16 a[184:185], v27 offset:20480
  ds_read_b64_tr_b16 a[186:187], v27 offset:22528
  s_waitcnt vmcnt(10)
  v_mfma_f32_32x32x16_bf16 v[140:155], a[208:211], a[52:55], v[140:155]
  ds_read_b64_tr_b16 a[188:189], v53 offset:20480
  ds_read_b64_tr_b16 a[190:191], v53 offset:22528
  s_waitcnt lgkmcnt(6)
  buffer_load_dwordx4 a[112:115], v51, s[32:35], s77 offen offset:1024 sc1
  v_mfma_f32_32x32x16_bf16 v[156:171], a[164:167], a[52:55], v[156:171]
  ds_read_b64_tr_b16 a[192:193], v45 offset:20480
  ds_read_b64_tr_b16 a[194:195], v45 offset:22528
  v_mfma_f32_32x32x16_bf16 v[108:123], a[168:171], a[52:55], v[108:123]
  ds_read_b64_tr_b16 a[196:197], v27 offset:24576
  ds_read_b64_tr_b16 a[198:199], v27 offset:26624
  buffer_load_dwordx4 a[124:127], v51, s[32:35], s77 offen offset:2048 sc1
  s_waitcnt vmcnt(11)
  v_mfma_f32_32x32x16_bf16 v[140:155], a[172:175], a[64:67], v[140:155]
  ds_read_b64_tr_b16 a[200:201], v53 offset:24576
  ds_read_b64_tr_b16 a[202:203], v53 offset:26624
  v_mfma_f32_32x32x16_bf16 v[156:171], a[176:179], a[64:67], v[156:171]
  ds_read_b64_tr_b16 a[204:205], v45 offset:24576
  ds_read_b64_tr_b16 a[206:207], v45 offset:26624
  s_barrier
  s_waitcnt lgkmcnt(6)
  v_mfma_f32_32x32x16_bf16 v[108:123], a[180:183], a[64:67], v[108:123]
  ds_read_b64_tr_b16 a[208:209], v27 offset:28672
  s_add_u32 m0, s66, 139264
  ds_read_b64_tr_b16 a[210:211], v27 offset:30720
  buffer_load_dwordx4 v136, s[24:27], s89 offen lds
  s_waitcnt vmcnt(11)
  v_mfma_f32_32x32x16_bf16 v[140:155], a[184:187], a[76:79], v[140:155]
  ds_read_b64_tr_b16 a[164:165], v27 offset:32768
  ds_read_b64_tr_b16 a[166:167], v27 offset:34816
  v_mfma_f32_32x32x16_bf16 v[156:171], a[188:191], a[76:79], v[156:171]
  ds_read_b64_tr_b16 a[168:169], v27 offset:36864
  s_add_u32 m0, s66, 151552
  ds_read_b64_tr_b16 a[170:171], v27 offset:38912
  buffer_load_dwordx4 v26, s[24:27], s89 offen lds
  v_mfma_f32_32x32x16_bf16 v[108:123], a[192:195], a[76:79], v[108:123]
  ds_read_b64_tr_b16 a[172:173], v27 offset:40960
  ds_read_b64_tr_b16 a[174:175], v27 offset:43008
  s_waitcnt lgkmcnt(6) vmcnt(11)
  v_mfma_f32_32x32x16_bf16 v[140:155], a[196:199], a[88:91], v[140:155]
  ds_read_b64_tr_b16 a[176:177], v27 offset:45056
  s_add_u32 m0, s66, 77824
  ds_read_b64_tr_b16 a[178:179], v27 offset:47104
  buffer_load_dwordx4 v136, s[28:31], s89 offen lds
  v_mfma_f32_32x32x16_bf16 v[156:171], a[200:203], a[88:91], v[156:171]
  ds_read_b64_tr_b16 a[180:181], v27 offset:49152
  ds_read_b64_tr_b16 a[182:183], v27 offset:51200
  v_mfma_f32_32x32x16_bf16 v[108:123], a[204:207], a[88:91], v[108:123]
  ds_read_b64_tr_b16 a[184:185], v27 offset:53248
  s_add_u32 m0, s66, 122880
  ds_read_b64_tr_b16 a[186:187], v27 offset:55296
  buffer_load_dwordx4 v26, s[28:31], s89 offen lds
  v_mfma_f32_32x32x8_bf16 a[20:35], v[240:241], v[80:81], 0
  s_waitcnt vmcnt(12)
  v_mfma_f32_32x32x16_bf16 v[140:155], a[208:211], a[92:95], v[140:155]
  ds_read_b64_tr_b16 a[188:189], v27 offset:57344
  ds_read_b64_tr_b16 a[190:191], v27 offset:59392
  s_waitcnt lgkmcnt(6) vmcnt(11)
  v_mfma_f32_32x32x16_bf16 v[140:155], a[164:167], a[104:107], v[140:155]
  ds_read_b64_tr_b16 a[192:193], v27 offset:61440
  ds_read_b64_tr_b16 a[194:195], v27 offset:63488
  s_waitcnt vmcnt(10)
  v_mfma_f32_32x32x16_bf16 v[140:155], a[168:171], a[116:119], v[140:155]
  ds_read_b64_tr_b16 a[196:197], v53 offset:28672
  ds_read_b64_tr_b16 a[198:199], v53 offset:30720
  s_waitcnt vmcnt(9)
  v_mfma_f32_32x32x16_bf16 v[140:155], a[172:175], a[96:99], v[140:155]
  ds_read_b64_tr_b16 a[200:201], v53 offset:32768
  ds_read_b64_tr_b16 a[202:203], v53 offset:34816
  s_waitcnt vmcnt(8)
  v_mfma_f32_32x32x16_bf16 v[140:155], a[176:179], a[108:111], v[140:155]
  ds_read_b64_tr_b16 a[204:205], v53 offset:36864
  ds_read_b64_tr_b16 a[206:207], v53 offset:38912
  s_waitcnt lgkmcnt(6) vmcnt(7)
  v_mfma_f32_32x32x16_bf16 v[140:155], a[180:183], a[120:123], v[140:155]
  ds_read_b64_tr_b16 a[208:209], v53 offset:40960
  ds_read_b64_tr_b16 a[210:211], v53 offset:43008
  s_waitcnt vmcnt(6)
  v_mfma_f32_32x32x16_bf16 v[140:155], a[184:187], a[100:103], v[140:155]
  ds_read_b64_tr_b16 a[164:165], v53 offset:45056
  ds_read_b64_tr_b16 a[166:167], v53 offset:47104
  s_waitcnt vmcnt(5)
  v_mfma_f32_32x32x16_bf16 v[140:155], a[188:191], a[112:115], v[140:155]
  ds_read_b64_tr_b16 a[168:169], v53 offset:49152
  ds_read_b64_tr_b16 a[170:171], v53 offset:51200
  s_waitcnt vmcnt(4)
  v_mfma_f32_32x32x16_bf16 v[140:155], a[192:195], a[124:127], v[140:155]
  ds_read_b64_tr_b16 a[172:173], v53 offset:53248
  ds_read_b64_tr_b16 a[174:175], v53 offset:55296
  s_waitcnt lgkmcnt(6)
  v_mfma_f32_32x32x16_bf16 v[156:171], a[196:199], a[92:95], v[156:171]
  ds_read_b64_tr_b16 a[176:177], v53 offset:57344
  ds_read_b64_tr_b16 a[178:179], v53 offset:59392
  v_mfma_f32_32x32x16_bf16 v[156:171], a[200:203], a[104:107], v[156:171]
  ds_read_b64_tr_b16 a[180:181], v53 offset:61440
  ds_read_b64_tr_b16 a[182:183], v53 offset:63488
  v_mfma_f32_32x32x16_bf16 v[156:171], a[204:207], a[116:119], v[156:171]
  ds_read_b128 a[184:187], v19 offset:20480
  s_nop 0
  v_cvt_pk_bf16_f32 v28, v140, v141
  v_cvt_pk_bf16_f32 v29, v142, v143
  v_cvt_pk_bf16_f32 v30, v144, v145
  v_cvt_pk_bf16_f32 v31, v146, v147
  v_mfma_f32_32x32x16_bf16 v[156:171], a[208:211], a[96:99], v[156:171]
  ds_read_b128 a[188:191], v21 offset:20480
  s_waitcnt lgkmcnt(4)
  v_cvt_pk_bf16_f32 v32, v148, v149
  v_cvt_pk_bf16_f32 v33, v150, v151
  v_cvt_pk_bf16_f32 v34, v152, v153
  v_mfma_f32_32x32x16_bf16 v[156:171], a[164:167], a[108:111], v[156:171]
  ds_read_b128 a[192:195], v255 offset:12288
  v_cvt_pk_bf16_f32 v35, v154, v155
  s_mul_i32 s76, s61, 7168
  buffer_store_dwordx4 v[28:31], v22, s[32:35], s76 offen offset:0 sc1
  buffer_store_dwordx4 v[32:35], v22, s[32:35], s76 offen offset:1024 sc1
  v_mfma_f32_32x32x16_bf16 v[156:171], a[168:171], a[120:123], v[156:171]
  ds_read_b128 a[196:199], v18 offset:12288
  v_mfma_f32_32x32x16_bf16 v[156:171], a[172:175], a[100:103], v[156:171]
  ds_read_b128 a[200:203], v20 offset:12288
  v_mfma_f32_32x32x16_bf16 v[156:171], a[176:179], a[112:115], v[156:171]
  ds_read_b128 a[204:207], v57 offset:12288
  s_waitcnt lgkmcnt(3)
  v_mfma_f32_32x32x16_bf16 v[156:171], a[180:183], a[124:127], v[156:171]
  ds_read_b64_tr_b16 a[208:209], v45 offset:28672
  ds_read_b64_tr_b16 a[210:211], v45 offset:30720
  v_mfma_f32_32x32x16_bf16 v[156:171], a[184:187], a[240:243], v[156:171]
  ds_read_b64_tr_b16 a[164:165], v45 offset:32768
  ds_read_b64_tr_b16 a[166:167], v45 offset:34816
  v_mfma_f32_32x32x16_bf16 v[156:171], a[188:191], a[252:255], v[156:171]
  ds_read_b64_tr_b16 a[168:169], v45 offset:36864
  ds_read_b64_tr_b16 a[170:171], v45 offset:38912
  v_mfma_f32_32x32x16_bf16 v[156:171], a[192:195], a[244:247], v[156:171]
  ds_read_b64_tr_b16 a[172:173], v45 offset:40960
  ds_read_b64_tr_b16 a[174:175], v45 offset:43008
  s_waitcnt lgkmcnt(6)
  v_mfma_f32_32x32x16_bf16 v[156:171], a[196:199], a[36:39], v[156:171]
  ds_read_b64_tr_b16 a[176:177], v45 offset:45056
  ds_read_b64_tr_b16 a[178:179], v45 offset:47104
  v_mfma_f32_32x32x16_bf16 v[156:171], a[200:203], a[248:251], v[156:171]
  ds_read_b64_tr_b16 a[180:181], v45 offset:49152
  ds_read_b64_tr_b16 a[182:183], v45 offset:51200
  v_mfma_f32_32x32x16_bf16 v[156:171], a[204:207], a[40:43], v[156:171]
  ds_read_b64_tr_b16 a[184:185], v45 offset:53248
  ds_read_b64_tr_b16 a[186:187], v45 offset:55296
  v_mfma_f32_32x32x16_bf16 v[108:123], a[208:211], a[92:95], v[108:123]
  ds_read_b64_tr_b16 a[188:189], v45 offset:57344
  ds_read_b64_tr_b16 a[190:191], v45 offset:59392
  s_waitcnt lgkmcnt(6)
  v_mfma_f32_32x32x16_bf16 v[108:123], a[164:167], a[104:107], v[108:123]
  ds_read_b64_tr_b16 a[192:193], v45 offset:61440
  ds_read_b64_tr_b16 a[194:195], v45 offset:63488
  v_mfma_f32_32x32x16_bf16 v[108:123], a[168:171], a[116:119], v[108:123]
  ds_read_b128 a[196:199], v19 offset:4096
  s_nop 0
  v_cvt_pk_bf16_f32 v36, v156, v157
  v_cvt_pk_bf16_f32 v37, v158, v159
  v_cvt_pk_bf16_f32 v38, v160, v161
  v_cvt_pk_bf16_f32 v39, v162, v163
  v_mfma_f32_32x32x16_bf16 v[108:123], a[172:175], a[96:99], v[108:123]
  ds_read_b128 a[200:203], v21 offset:4096
  v_cvt_pk_bf16_f32 v40, v164, v165
  v_cvt_pk_bf16_f32 v41, v166, v167
  v_cvt_pk_bf16_f32 v42, v168, v169
  v_cvt_pk_bf16_f32 v43, v170, v171
  v_mfma_f32_32x32x16_bf16 v[108:123], a[176:179], a[108:111], v[108:123]
  ds_read_b128 a[204:207], v19 offset:24576
  s_waitcnt lgkmcnt(3)
  s_add_u32 s76, s76, 2048
  buffer_store_dwordx4 v[36:39], v22, s[32:35], s76 offen offset:0 sc1
  buffer_store_dwordx4 v[40:43], v22, s[32:35], s76 offen offset:1024 sc1
  v_mfma_f32_32x32x16_bf16 v[108:123], a[180:183], a[120:123], v[108:123]
  ds_read_b128 a[208:211], v21 offset:24576
  v_mfma_f32_32x32x16_bf16 v[108:123], a[184:187], a[100:103], v[108:123]
  ds_read_b128 a[164:167], v255 offset:16384
  v_mfma_f32_32x32x16_bf16 v[108:123], a[188:191], a[112:115], v[108:123]
  ds_read_b128 a[168:171], v18 offset:16384
  v_mfma_f32_32x32x16_bf16 v[108:123], a[192:195], a[124:127], v[108:123]
  ds_read_b128 a[172:175], v20 offset:16384
  s_waitcnt lgkmcnt(3)
  v_mfma_f32_32x32x16_bf16 v[108:123], a[196:199], a[224:227], v[108:123]
  ds_read_b128 a[176:179], v57 offset:16384
  v_add_u32 v66, 1, v66
  s_waitcnt vmcnt(2)
  buffer_store_dwordx2 v[66:67], v134, s[32:35], s8 offen sc1
  v_mfma_f32_32x32x16_bf16 v[108:123], a[200:203], a[236:239], v[108:123]
  ds_read_b64_tr_b16 a[180:181], v252 offset:40960
  ds_read_b64_tr_b16 a[182:183], v252 offset:43008
  v_mfma_f32_32x32x16_bf16 v[108:123], a[204:207], a[240:243], v[108:123]
  ds_read_b64_tr_b16 a[184:185], v252 offset:45056
  ds_read_b64_tr_b16 a[186:187], v252 offset:47104
  v_mfma_f32_32x32x16_bf16 v[108:123], a[208:211], a[252:255], v[108:123]
  ds_read_b64_tr_b16 a[188:189], v252 offset:49152
  ds_read_b64_tr_b16 a[190:191], v252 offset:51200
  s_waitcnt lgkmcnt(6)
  v_mfma_f32_32x32x16_bf16 v[108:123], a[164:167], a[244:247], v[108:123]
  ds_read_b64_tr_b16 a[192:193], v252 offset:53248
  ds_read_b64_tr_b16 a[194:195], v252 offset:55296
  v_mfma_f32_32x32x16_bf16 v[108:123], a[168:171], a[36:39], v[108:123]
  ds_read_b64_tr_b16 a[196:197], v252 offset:0
  ds_read_b64_tr_b16 a[198:199], v252 offset:2048
  v_mfma_f32_32x32x16_bf16 v[108:123], a[172:175], a[248:251], v[108:123]
  ds_read_b64_tr_b16 a[200:201], v252 offset:4096
  ds_read_b64_tr_b16 a[202:203], v252 offset:6144
  v_mfma_f32_32x32x16_bf16 v[108:123], a[176:179], a[40:43], v[108:123]
  ds_read_b64_tr_b16 a[204:205], v252 offset:8192
  ds_read_b64_tr_b16 a[206:207], v252 offset:10240
  s_waitcnt lgkmcnt(6)
  v_mfma_f32_32x32x16_bf16 a[20:35], v[172:175], a[180:183], a[20:35]
  ds_read_b64_tr_b16 a[208:209], v252 offset:20480
  ds_read_b64_tr_b16 a[210:211], v252 offset:22528
  v_mfma_f32_32x32x16_bf16 a[20:35], v[176:179], a[184:187], a[20:35]
  ds_read_b64_tr_b16 a[164:165], v252 offset:24576
  ds_read_b64_tr_b16 a[166:167], v252 offset:26624
  v_mfma_f32_32x32x16_bf16 a[20:35], v[180:183], a[188:191], a[20:35]
  ds_read_b64_tr_b16 a[168:169], v252 offset:28672
  ds_read_b64_tr_b16 a[170:171], v252 offset:30720
  v_cvt_pk_bf16_f32 v28, v108, v109
  v_cvt_pk_bf16_f32 v29, v110, v111
  v_cvt_pk_bf16_f32 v30, v112, v113
  v_mfma_f32_32x32x16_bf16 a[20:35], v[184:187], a[192:195], a[20:35]
  ds_read_b64_tr_b16 a[172:173], v253 offset:0
  ds_read_b64_tr_b16 a[174:175], v253 offset:2048
  s_waitcnt lgkmcnt(6)
  v_cvt_pk_bf16_f32 v31, v114, v115
  v_cvt_pk_bf16_f32 v32, v116, v117
  v_mfma_f32_32x32x16_bf16 a[20:35], v[188:191], a[196:199], a[20:35]
  ds_read_b64_tr_b16 a[176:177], v253 offset:4096
  ds_read_b64_tr_b16 a[178:179], v253 offset:6144
  v_cvt_pk_bf16_f32 v33, v118, v119
  v_cvt_pk_bf16_f32 v34, v120, v121
  v_cvt_pk_bf16_f32 v35, v122, v123
  v_mfma_f32_32x32x16_bf16 a[20:35], v[192:195], a[200:203], a[20:35]
  ds_read_b64_tr_b16 a[180:181], v48 offset:0
  ds_read_b64_tr_b16 a[182:183], v48 offset:2048
  s_add_u32 s76, s76, 2048
  buffer_store_dwordx4 v[28:31], v22, s[32:35], s76 offen offset:0 sc1
  buffer_store_dwordx4 v[32:35], v22, s[32:35], s76 offen offset:1024 sc1
  v_mfma_f32_32x32x16_bf16 a[20:35], v[196:199], a[204:207], a[20:35]
  ds_read_b64_tr_b16 a[184:185], v48 offset:4096
  ds_read_b64_tr_b16 a[186:187], v48 offset:6144
  v_mfma_f32_32x32x16_bf16 a[20:35], a[44:47], a[208:211], a[20:35]
  ds_read_b64_tr_b16 a[188:189], v48 offset:8192
  ds_read_b64_tr_b16 a[190:191], v48 offset:10240
  s_waitcnt lgkmcnt(6)
  v_mfma_f32_32x32x16_bf16 a[20:35], a[56:59], a[164:167], a[20:35]
  ds_read_b64_tr_b16 a[192:193], v48 offset:12288
  ds_read_b64_tr_b16 a[194:195], v48 offset:14336
  v_mfma_f32_32x32x16_bf16 a[20:35], a[68:71], a[168:171], a[20:35]
  ds_read_b64_tr_b16 a[196:197], v48 offset:16384
  ds_read_b64_tr_b16 a[198:199], v48 offset:18432
  s_waitcnt vmcnt(3)
  buffer_store_dwordx2 v[66:67], v134, s[32:35], s9 offen sc1
  v_mfma_f32_32x32x16_bf16 a[20:35], a[80:83], a[172:175], a[20:35]
  ds_read_b64_tr_b16 a[200:201], v48 offset:20480
  ds_read_b64_tr_b16 a[202:203], v48 offset:22528
  s_load_dwordx2 s[52:53], s[14:15], 0 glc
  v_mfma_f32_32x32x16_bf16 a[20:35], a[48:51], a[176:179], a[20:35]
  ds_read_b64_tr_b16 a[204:205], v48 offset:24576
  ds_read_b64_tr_b16 a[206:207], v48 offset:26624
  s_waitcnt lgkmcnt(6)
  v_mfma_f32_32x32x16_bf16 a[20:35], a[60:63], a[180:183], a[20:35]
  ds_read_b64_tr_b16 a[208:209], v48 offset:28672
  ds_read_b64_tr_b16 a[210:211], v48 offset:30720
  v_mfma_f32_32x32x16_bf16 a[20:35], a[72:75], a[184:187], a[20:35]
  ds_read_b64_tr_b16 a[164:165], v48 offset:32768
  ds_read_b64_tr_b16 a[166:167], v48 offset:34816
  v_mfma_f32_32x32x16_bf16 a[20:35], a[84:87], a[188:191], a[20:35]
  ds_read_b64_tr_b16 a[168:169], v48 offset:36864
  ds_read_b64_tr_b16 a[170:171], v48 offset:38912
  v_mfma_f32_32x32x16_bf16 a[20:35], a[52:55], a[192:195], a[20:35]
  ds_read_b64_tr_b16 a[172:173], v48 offset:40960
  ds_read_b64_tr_b16 a[174:175], v48 offset:43008
  s_waitcnt lgkmcnt(6)
  v_mfma_f32_32x32x16_bf16 a[20:35], a[64:67], a[196:199], a[20:35]
  ds_read_b64_tr_b16 a[176:177], v48 offset:45056
  ds_read_b64_tr_b16 a[178:179], v48 offset:47104
  v_mfma_f32_32x32x16_bf16 a[20:35], a[76:79], a[200:203], a[20:35]
  ds_read_b64_tr_b16 a[180:181], v48 offset:49152
  ds_read_b64_tr_b16 a[182:183], v48 offset:51200
  v_mfma_f32_32x32x16_bf16 a[20:35], a[88:91], a[204:207], a[20:35]
  ds_read_b64_tr_b16 a[184:185], v48 offset:53248
  ds_read_b64_tr_b16 a[186:187], v48 offset:55296
  v_mfma_f32_32x32x16_bf16 a[20:35], a[92:95], a[208:211], a[20:35]
  ds_read_b64_tr_b16 a[188:189], v48 offset:57344
  ds_read_b64_tr_b16 a[190:191], v48 offset:59392
  s_waitcnt lgkmcnt(6)
  v_mfma_f32_32x32x16_bf16 a[20:35], a[104:107], a[164:167], a[20:35]
  ds_read_b64_tr_b16 a[192:193], v48 offset:61440
  ds_read_b64_tr_b16 a[194:195], v48 offset:63488
  s_barrier
  v_mfma_f32_32x32x16_bf16 a[20:35], a[116:119], a[168:171], a[20:35]
  ds_read_b128 a[196:199], v254 offset:61440
  v_mfma_f32_32x32x16_bf16 a[20:35], a[96:99], a[172:175], a[20:35]
  ds_read_b128 a[200:203], v17 offset:61440
  v_mfma_f32_32x32x16_bf16 a[20:35], a[108:111], a[176:179], a[20:35]
  ds_read_b128 a[204:207], v19 offset:61440
  s_waitcnt lgkmcnt(3)
  v_mfma_f32_32x32x16_bf16 a[20:35], a[120:123], a[180:183], a[20:35]
  ds_read_b128 a[208:211], v21 offset:61440
  v_mfma_f32_32x32x16_bf16 a[20:35], a[100:103], a[184:187], a[20:35]
  ds_read_b128 a[164:167], v255 offset:8192
  s_waitcnt vmcnt(1)
  buffer_store_dwordx2 v[66:67], v134, s[32:35], s10 offen sc1
  v_mfma_f32_32x32x16_bf16 a[20:35], a[112:115], a[188:191], a[20:35]
  ds_read_b128 a[168:171], v18 offset:8192
  s_add_u32 s50, s50, 1
  s_waitcnt lgkmcnt(0)
  s_cmp_lg_u64 s[52:53], s[50:51]
  s_cbranch_scc1 L_sp7
L_ok7:
  s_load_dwordx2 s[56:57], s[14:15], 16 glc
  v_mfma_f32_32x32x16_bf16 a[20:35], a[124:127], a[192:195], a[20:35]
  ds_read_b128 a[172:175], v20 offset:8192
  s_xor_b32 s77, s61, 12
  s_mul_i32 s77, s77, 7168
  buffer_load_dwordx4 a[128:131], v22, s[32:35], s77 offen offset:0 sc1
  v_mfma_f32_32x32x16_bf16 a[20:35], v[244:247], a[196:199], a[20:35]
  ds_read_b128 a[176:179], v57 offset:8192
  buffer_load_dwordx4 a[132:135], v22, s[32:35], s77 offen offset:1024 sc1
  v_mfma_f32_32x32x16_bf16 a[20:35], v[248:251], a[200:203], a[20:35]
  ds_read_b128 a[180:183], v254 offset:0
  v_mfma_f32_32x32x16_bf16 a[20:35], a[216:219], a[204:207], a[20:35]
  ds_read_b128 a[184:187], v17 offset:0
  v_mfma_f32_32x32x16_bf16 a[20:35], a[228:231], a[208:211], a[20:35]
  ds_read_b128 a[188:191], v19 offset:0
  s_waitcnt lgkmcnt(3)
  v_mfma_f32_32x32x16_bf16 a[20:35], a[220:223], a[164:167], a[20:35]
  ds_read_b128 a[192:195], v21 offset:0
  v_mfma_f32_32x32x16_bf16 a[20:35], a[232:235], a[168:171], a[20:35]
  ds_read_b128 a[196:199], v254 offset:45056
  v_mfma_f32_32x32x16_bf16 a[20:35], a[224:227], a[172:175], a[20:35]
  ds_read_b128 a[200:203], v17 offset:45056
  v_mfma_f32_32x32x16_bf16 a[20:35], a[236:239], a[176:179], a[20:35]
  ds_read_b128 a[204:207], v19 offset:45056
  ds_read_b128 a[208:211], v21 offset:45056
  s_waitcnt lgkmcnt(4)
  v_mfma_f32_32x32x16_bf16 a[20:35], v[124:127], a[180:183], a[20:35]
  v_mfma_f32_32x32x16_bf16 a[20:35], v[128:131], a[184:187], a[20:35]
  s_waitcnt lgkmcnt(0)
  s_cmp_lg_u64 s[56:57], s[50:51]
  s_cbranch_scc1 L_sp8
L_ok8:
  s_load_dwordx2 s[58:59], s[14:15], 24 glc
  v_mfma_f32_32x32x16_bf16 a[20:35], a[240:243], a[188:191], a[20:35]
  s_xor_b32 s77, s61, 8
  s_mul_i32 s77, s77, 7168
  s_add_u32 s77, s77, 2048
  buffer_load_dwordx4 a[136:139], v22, s[32:35], s77 offen offset:0 sc1
  v_mfma_f32_32x32x16_bf16 a[20:35], a[252:255], a[192:195], a[20:35]
  buffer_load_dwordx4 a[140:143], v22, s[32:35], s77 offen offset:1024 sc1
  v_mfma_f32_32x32x16_bf16 a[20:35], a[244:247], a[196:199], a[20:35]
  s_xor_b32 s77, s61, 4
  s_mul_i32 s77, s77, 7168
  s_add_u32 s77, s77, 4096
  v_mfma_f32_32x32x16_bf16 a[20:35], a[36:39], a[200:203], a[20:35]
  v_mfma_f32_32x32x16_bf16 a[20:35], a[248:251], a[204:207], a[20:35]
  v_mfma_f32_32x32x16_bf16 a[20:35], a[40:43], a[208:211], a[20:35]
  v_mfma_f32_32x32x16_bf16 a[20:35], v[92:95], v[84:87], a[20:35]
  v_mfma_f32_32x32x16_bf16 a[20:35], a[4:7], a[12:15], a[20:35]
  v_mfma_f32_32x32x16_bf16 a[20:35], v[96:99], v[88:91], a[20:35]
  v_mfma_f32_32x32x16_bf16 a[20:35], a[8:11], a[16:19], a[20:35]
  s_waitcnt vmcnt(3)
  v_mfma_f32_32x32x16_bf16 a[20:35], a[128:131], a[12:15], a[20:35]
  s_waitcnt vmcnt(2)
  v_mfma_f32_32x32x16_bf16 a[20:35], a[132:135], a[16:19], a[20:35]
  s_waitcnt lgkmcnt(0)
  s_cmp_lg_u64 s[58:59], s[50:51]
  s_cbranch_scc1 L_sp9
L_ok9:
  buffer_load_dwordx4 a[144:147], v22, s[32:35], s77 offen offset:0 sc1
  buffer_load_dwordx4 a[148:151], v22, s[32:35], s77 offen offset:1024 sc1
  s_waitcnt vmcnt(3)
  v_mfma_f32_32x32x16_bf16 a[20:35], a[136:139], a[12:15], a[20:35]
  s_waitcnt vmcnt(2)
  v_mfma_f32_32x32x16_bf16 a[20:35], a[140:143], a[16:19], a[20:35]
  s_waitcnt vmcnt(1)
  v_mfma_f32_32x32x16_bf16 a[20:35], a[144:147], a[12:15], a[20:35]
  s_waitcnt vmcnt(0)
  v_mfma_f32_32x32x16_bf16 a[20:35], a[148:151], a[16:19], a[20:35]
  s_nop 11
  buffer_store_dword a20, v23, s[36:39], 0 offen offset:0 sc1 nt
  buffer_store_dword a21, v24, s[36:39], 0 offen offset:0 sc1 nt
  buffer_store_dword a22, v23, s[36:39], 0 offen offset:2048 sc1 nt
  buffer_store_dword a23, v24, s[36:39], 0 offen offset:2048 sc1 nt
  buffer_store_dword a24, v23, s[36:39], s90 offen offset:0 sc1 nt
  buffer_store_dword a25, v24, s[36:39], s90 offen offset:0 sc1 nt
  buffer_store_dword a26, v23, s[36:39], s90 offen offset:2048 sc1 nt
  buffer_store_dword a27, v24, s[36:39], s90 offen offset:2048 sc1 nt
  buffer_store_dword a28, v23, s[36:39], s91 offen offset:0 sc1 nt
  buffer_store_dword a29, v24, s[36:39], s91 offen offset:0 sc1 nt
  buffer_store_dword a30, v23, s[36:39], s91 offen offset:2048 sc1 nt
  buffer_store_dword a31, v24, s[36:39], s91 offen offset:2048 sc1 nt
  buffer_store_dword a32, v23, s[36:39], s92 offen offset:0 sc1 nt
  buffer_store_dword a33, v24, s[36:39], s92 offen offset:0 sc1 nt
  buffer_store_dword a34, v23, s[36:39], s92 offen offset:2048 sc1 nt
  buffer_store_dword a35, v24, s[36:39], s92 offen offset:2048 sc1 nt
  s_endpgm
L_sp9:
  s_mov_b32 s75, 200000
L_sq9:
  s_load_dwordx2 s[58:59], s[14:15], 24 glc
L_sr9:
  s_waitcnt lgkmcnt(0)
  s_cmp_lg_u64 s[58:59], s[50:51]
  s_cbranch_scc0 L_ok9
  s_sub_u32 s75, s75, 1
  s_cbranch_scc0 L_sq9
  s_branch L_ok9
L_sp8:
  s_mov_b32 s75, 200000
L_sq8:
  s_load_dwordx2 s[56:57], s[14:15], 16 glc
L_sr8:
  s_waitcnt lgkmcnt(0)
  s_cmp_lg_u64 s[56:57], s[50:51]
  s_cbranch_scc0 L_ok8
  s_sub_u32 s75, s75, 1
  s_cbranch_scc0 L_sq8
  s_branch L_ok8
L_sp7:
  s_mov_b32 s75, 200000
L_sq7:
  s_load_dwordx2 s[52:53], s[14:15], 0 glc
L_sr7:
  s_waitcnt lgkmcnt(0)
  s_cmp_lg_u64 s[52:53], s[50:51]
  s_cbranch_scc0 L_ok7
  s_sub_u32 s75, s75, 1
  s_cbranch_scc0 L_sq7
  s_branch L_ok7
L_sp6:
  s_mov_b32 s75, 200000
L_sq6:
  s_load_dwordx8 s[52:59], s[12:13], 256 glc
L_sr6:
  s_waitcnt lgkmcnt(0)
  s_xor_b64 s[40:41], s[52:53], s[50:51]
  s_xor_b64 s[16:17], s[54:55], s[50:51]
  s_or_b64 s[40:41], s[40:41], s[16:17]
  s_xor_b64 s[16:17], s[56:57], s[50:51]
  s_or_b64 s[40:41], s[40:41], s[16:17]
  s_xor_b64 s[16:17], s[58:59], s[50:51]
  s_or_b64 s[40:41], s[40:41], s[16:17]
  s_cbranch_scc0 L_ok6
  s_sub_u32 s75, s75, 1
  s_cbranch_scc0 L_sq6
  s_branch L_ok6
L_sp5:
  s_mov_b32 s75, 200000
L_sq5:
  s_load_dwordx8 s[52:59], s[12:13], 128 glc
L_sr5:
  s_waitcnt lgkmcnt(0)
  s_xor_b64 s[40:41], s[52:53], s[50:51]
  s_xor_b64 s[16:17], s[54:55], s[50:51]
  s_or_b64 s[40:41], s[40:41], s[16:17]
  s_xor_b64 s[16:17], s[56:57], s[50:51]
  s_or_b64 s[40:41], s[40:41], s[16:17]
  s_xor_b64 s[16:17], s[58:59], s[50:51]
  s_or_b64 s[40:41], s[40:41], s[16:17]
  s_cbranch_scc0 L_ok5
  s_sub_u32 s75, s75, 1
  s_cbranch_scc0 L_sq5
  s_branch L_ok5
L_sp4:
  s_mov_b32 s75, 200000
L_sq4:
  s_load_dwordx8 s[52:59], s[12:13], 0 glc
L_sr4:
  s_waitcnt lgkmcnt(0)
  s_xor_b64 s[40:41], s[52:53], s[50:51]
  s_xor_b64 s[16:17], s[54:55], s[50:51]
  s_or_b64 s[40:41], s[40:41], s[16:17]
  s_xor_b64 s[16:17], s[56:57], s[50:51]
  s_or_b64 s[40:41], s[40:41], s[16:17]
  s_xor_b64 s[16:17], s[58:59], s[50:51]
  s_or_b64 s[40:41], s[40:41], s[16:17]
  s_cbranch_scc0 L_ok4
  s_sub_u32 s75, s75, 1
  s_cbranch_scc0 L_sq4
  s_branch L_ok4
L_sp3:
  s_mov_b32 s75, 200000
L_sq3:
  buffer_load_dwordx2 v[28:29], v125, s[40:43], 0 offen offset:256 sc0 sc1
  buffer_load_dwordx2 v[30:31], v125, s[40:43], 0 offen offset:512 sc0 sc1
L_sr3:
  s_waitcnt vmcnt(0)
  v_xor_b32 v4, v28, v137
  v_bitop3_b32 v4, v4, v29, v137 bitop3:0xf6
  v_bitop3_b32 v4, v4, v30, v137 bitop3:0xf6
  v_bitop3_b32 v4, v4, v31, v137 bitop3:0xf6
  v_and_b32 v4, 0x3ff, v4
  v_cmp_ne_u32 vcc, 0, v4
  s_cbranch_vccz L_ok3
  s_sub_u32 s75, s75, 1
  s_cbranch_scc0 L_sq3
  s_branch L_ok3
L_sp2:
  s_mov_b32 s75, 200000
L_sq2:
  buffer_load_dwordx4 v[28:31], v44, s[32:35], 0 offen sc1
  buffer_load_dwordx4 v[32:35], v49, s[32:35], 0 offen sc1
L_sr2:
  s_waitcnt vmcnt(0)
  v_xor_b32 v4, v29, v66
  v_bitop3_b32 v4, v4, v31, v67 bitop3:0xf6
  v_bitop3_b32 v4, v4, v33, v66 bitop3:0xf6
  v_bitop3_b32 v4, v4, v35, v67 bitop3:0xf6
  v_cmp_ne_u32 vcc, 0, v4
  s_cbranch_vccz L_ok2
  s_sub_u32 s75, s75, 1
  s_cbranch_scc0 L_sq2
  s_branch L_ok2
L_sp1:
  s_mov_b32 s75, 200000
L_sq1:
  v_mov_b32 v4, 0
  buffer_load_dwordx2 v[66:67], v4, s[44:47], 0 offen sc0 sc1
  s_waitcnt vmcnt(0)
  v_readfirstlane_b32 s50, v66
  v_readfirstlane_b32 s51, v67
  s_nop 4
L_sr1:
  s_waitcnt lgkmcnt(0)
  s_and_b32 s68, s50, s51
  s_bitcmp0_b32 s68, 31
  s_cbranch_scc0 L_ok1
  s_sub_u32 s75, s75, 1
  s_cbranch_scc0 L_sq1
  s_branch L_ok1
L_xb7:
  v_xor_b32 v101, 16, v65
  v_xor_b32 v102, 32, v65
  v_xor_b32 v103, 48, v65
  ds_read_b64 a[4:5], v65 offset:16384
  ds_read_b64 a[6:7], v101 offset:16384
  ds_read_b64 a[8:9], v102 offset:16384
  ds_read_b64 a[10:11], v103 offset:16384
  s_branch L_xr7
L_xb6:
  v_xor_b32 v101, 16, v65
  v_xor_b32 v102, 32, v65
  v_xor_b32 v103, 48, v65
  ds_read_b64 a[4:5], v65 offset:0
  ds_read_b64 a[6:7], v101 offset:0
  ds_read_b64 a[8:9], v102 offset:0
  ds_read_b64 a[10:11], v103 offset:0
  s_branch L_xr6
L_xb5:
  v_xor_b32 v101, 16, v65
  v_xor_b32 v102, 32, v65
  v_xor_b32 v103, 48, v65
  ds_read_b64 a[4:5], v65 offset:32768
  ds_read_b64 a[6:7], v101 offset:32768
  ds_read_b64 a[8:9], v102 offset:32768
  ds_read_b64 a[10:11], v103 offset:32768
  s_branch L_xr5
L_xb4:
  v_xor_b32 v101, 16, v65
  v_xor_b32 v102, 32, v65
  v_xor_b32 v103, 48, v65
  ds_read_b64 a[4:5], v65 offset:16384
  ds_read_b64 a[6:7], v101 offset:16384
  ds_read_b64 a[8:9], v102 offset:16384
  ds_read_b64 a[10:11], v103 offset:16384
  s_branch L_xr4
L_xb3:
  v_xor_b32 v101, 16, v65
  v_xor_b32 v102, 32, v65
  v_xor_b32 v103, 48, v65
  ds_read_b64 a[4:5], v65 offset:0
  ds_read_b64 a[6:7], v101 offset:0
  ds_read_b64 a[8:9], v102 offset:0
  ds_read_b64 a[10:11], v103 offset:0
  s_branch L_xr3
L_xb2:
  v_xor_b32 v101, 16, v65
  v_xor_b32 v102, 32, v65
  v_xor_b32 v103, 48, v65
  ds_read_b64 a[4:5], v65 offset:32768
  ds_read_b64 a[6:7], v101 offset:32768
  ds_read_b64 a[8:9], v102 offset:32768
  ds_read_b64 a[10:11], v103 offset:32768
  s_branch L_xr2
L_xb1:
  v_xor_b32 v101, 16, v65
  v_xor_b32 v102, 32, v65
  v_xor_b32 v103, 48, v65
  ds_read_b64 a[4:5], v65 offset:16384
  ds_read_b64 a[6:7], v101 offset:16384
  ds_read_b64 a[8:9], v102 offset:16384
  ds_read_b64 a[10:11], v103 offset:16384
  s_branch L_xr1
L_xb0:
  v_xor_b32 v101, 16, v65
  v_xor_b32 v102, 32, v65
  v_xor_b32 v103, 48, v65
  ds_read_b64 a[4:5], v65 offset:0
  ds_read_b64 a[6:7], v101 offset:0
  ds_read_b64 a[8:9], v102 offset:0
  ds_read_b64 a[10:11], v103 offset:0
  s_branch L_xr0
L_pub:
  s_lshl_b32 s68, s92, 3
  s_lshr_b64 s[92:93], s[92:93], 28
  s_lshl_b32 s69, s92, 3
  s_bitset1_b32 s68, 31
  s_bitset1_b32 s69, 31
  v_mov_b32 v66, s68
  v_mov_b32 v67, s69
  v_lshlrev_b32 v5, 3, v0
  buffer_store_dwordx2 v[66:67], v5, s[44:47], 0 offen sc0 sc1
  s_branch L_pubr
L_end:
  s_endpgm
.section .rodata,"a"
.p2align 6
.amdhsa_kernel parallel_sum__ssm_conv_s5__mixer_channel_mlp__prompt_kernel
  .amdhsa_next_free_vgpr 512
  .amdhsa_next_free_sgpr 102
  .amdhsa_accum_offset 256
  .amdhsa_group_segment_fixed_size 0
  .amdhsa_kernarg_size 136
  .amdhsa_user_sgpr_count 2
  .amdhsa_user_sgpr_kernarg_segment_ptr 1
  .amdhsa_system_sgpr_workgroup_id_x 1
.end_amdhsa_kernel
```
